```python
import torch

def _softmax(x, axis=-1):
    return torch.softmax(x, dim=axis)
def _gelu(x):
    return torch.nn.functional.gelu(x, approximate="tanh")
def _silu(x):
    return torch.nn.functional.silu(x)
def _sigmoid(x):
    return torch.sigmoid(x)
def _layernorm(x, axis=-1, eps=1e-5):
    m = x.mean(dim=axis, keepdim=True)
    v = x.var(dim=axis, keepdim=True, unbiased=False)
    return (x - m) / torch.sqrt(v + eps)
def _scatter_add(tgt, idx, src, axis=0):
    return tgt.clone().index_add_(axis, idx, src)
def _segment_sum(src, seg, n):
    out = torch.zeros((n,) + src.shape[1:], dtype=src.dtype)
    return out.index_add_(0, seg, src)
def _pad(x, pw):
    flat = tuple(v for pair in reversed(pw) for v in pair)
    return torch.nn.functional.pad(x, flat)

kernel_name = 'gated_mix__sliding_local_dilated__dense_activation_relu__prompt'

def setup_inputs():

    _w = (lambda a: (lambda t: t.to(torch.bfloat16) if t.is_floating_point() else t)(torch.as_tensor(a)))
    def _A_setup():
        B, S, D = 1, 2048, 640
        return {
            "x": _w((lambda *s: torch.randn(*s, dtype=torch.bfloat16) * 0.05)(B, S, D)),
            "wqkv": _w((lambda *s: torch.randn(*s, dtype=torch.bfloat16) * 0.8)(D, 3 * D)),
            "wo": _w((lambda *s: torch.randn(*s, dtype=torch.bfloat16) * 0.05)(D, D)),
        }
    _A_in = _A_setup()

    def _B_setup():
        B, S, D, Dff = 1, 2048, 640, 1536
        return {
            "x": _w((lambda *s: torch.randn(*s, dtype=torch.bfloat16) * 0.05)(B, S, D)),
            "w1": _w((lambda *s: torch.randn(*s, dtype=torch.bfloat16) * 0.2)(D, Dff)),
            "w2": _w((lambda *s: torch.randn(*s, dtype=torch.bfloat16) * 0.2)(Dff, D)),
        }
    _B_in = _B_setup()

    return {
        "A_x": _A_in["x"],
        "A_wqkv": _A_in["wqkv"],
        "A_wo": _A_in["wo"],
        "B_x": _B_in["x"],
        "B_w1": _B_in["w1"],
        "B_w2": _B_in["w2"],
        "gate_w": _w((lambda *s: torch.randn(*s, dtype=torch.bfloat16) * 0.05)(640) * 16.0),
    }

def reference(A_x, A_wqkv, A_wo, B_x, B_w1, B_w2, gate_w):
    def _A_ref(x, wqkv, wo):
        B, S, D = x.shape
        H = 32; Dh = D // H
        W, dil = 8, 2
        qkv = (lambda x, *d: x.permute(*d))((x @ wqkv).reshape(B, S, 3, H, Dh), 2, 0, 3, 1, 4)
        q, k, v = qkv[0], qkv[1], qkv[2]
        scale = Dh ** -0.5
        pos = torch.arange(S)
        off = torch.arange(W) * dil
        idx = pos[:, None] - off[None, :]
        mask = idx >= 0
        idx_c = torch.where(mask, idx, 0).reshape(-1)
        kg = k[:, :, idx_c, :].reshape(B, H, S, W, Dh)
        vg = v[:, :, idx_c, :].reshape(B, H, S, W, Dh)
        logits = torch.einsum("bhsd,bhswd->bhsw", q, kg) * scale
        logits = torch.where(mask[None, None, :, :], logits, -1e9)
        attn = _softmax(logits, axis=-1)
        o = torch.einsum("bhsw,bhswd->bhsd", attn, vg)
        return (lambda x, *d: x.permute(*d))(o, 0, 2, 1, 3).reshape(B, S, D) @ wo

    def _B_ref(x, w1, w2):
        h = torch.einsum("bsd,df->bsf", x, w1)
        zero = torch.zeros_like(h)
        h = torch.maximum(h, zero)
        return torch.einsum("bsf,fd->bsd", h, w2)

    x = A_x
    g = _sigmoid((x * gate_w).sum(-1, keepdims=True))
    a = _A_ref(x, A_wqkv, A_wo)
    b = _B_ref(x, B_w1, B_w2)
    return g * a + (1 - g) * b
```

```asm
; @launch grid=(256,1,1) block=(512,1,1) lds=163840
.amdgcn_target "amdgcn-amd-amdhsa--gfx950"
.text
.globl gated_mix__sliding_local_dilated__dense_activation_relu__prompt_kernel
.p2align 8
.type gated_mix__sliding_local_dilated__dense_activation_relu__prompt_kernel,@function
gated_mix__sliding_local_dilated__dense_activation_relu__prompt_kernel:
    s_cmp_ge_u32 s2, 256
    s_cbranch_scc1 K_END
    s_load_dwordx8 s[4:11], s[0:1], 0
    s_load_dwordx4 s[12:15], s[0:1], 32
    s_load_dwordx2 s[16:17], s[0:1], 48
    s_load_dwordx2 s[18:19], s[0:1], 72
    s_load_dwordx2 s[60:61], s[0:1], 56
    s_load_dwordx2 s[62:63], s[0:1], 64
    v_lshrrev_b32 v1, 6, v0
    v_and_b32 v254, 63, v0
    v_readfirstlane_b32 s20, v1
    s_and_b32 s21, s2, 7
    s_lshr_b32 s22, s2, 3
    s_cmp_ge_u32 s22, 30
    s_cbranch_scc1 K_SPARE
    s_cmp_ge_u32 s22, 18
    s_cbranch_scc1 K_FFN
    s_and_b32 s46, s21, 1
    s_and_b32 s21, s21, 6
    s_cmp_ge_u32 s22, 9
    s_addc_u32 s21, s21, 0
    s_cmp_ge_u32 s22, 9
    s_cselect_b32 s47, 9, 0
    s_sub_u32 s22, s22, s47
    s_mul_i32 s46, s46, 9
    s_add_u32 s22, s22, s46
    s_mul_i32 s23, s22, 114
    s_sub_u32 s23, s23, 14
    s_cmp_lt_u32 s20, 4
    s_cbranch_scc1 QKV_C
    s_sub_u32 s20, s20, 4
    s_lshl_b32 s40, s20, 12
    s_add_u32 s41, s40, 32768
    s_add_u32 s48, s21, s22
    s_mul_i32 s49, s48, 256
    s_lshr_b32 s49, s49, 10
    s_mul_i32 s49, s49, 4
    s_sub_u32 s48, s48, s49
    s_mul_i32 s46, s21, 160
    s_lshl_b32 s47, s20, 8
    v_add_u32 v2, s47, v254
    v_mul_u32_u24 v3, 2185, v2
    v_lshrrev_b32 v3, 16, v3
    v_mul_u32_u24 v4, 30, v3
    v_sub_u32 v4, v2, v4
    v_mul_u32_u24 v5, 205, v4
    v_lshrrev_b32 v5, 11, v5
    v_and_b32 v6, 0x33, v3
    v_and_b32 v7, 4, v3
    v_lshl_or_b32 v6, v7, 1, v6
    v_and_b32 v7, 8, v3
    v_lshrrev_b32 v7, 1, v7
    v_or_b32 v6, v7, v6
    v_mul_u32_u24 v6, 3840, v6
    v_mul_u32_u24 v5, 1120, v5
    v_lshl_add_u32 v6, v4, 4, v6
    v_add3_u32 v10, v6, v5, s46
    s_sub_u32 s46, s46, 1024
    v_add_u32 v2, s47, v254
    v_add_u32 v2, 64, v2
    v_mul_u32_u24 v3, 2185, v2
    v_lshrrev_b32 v3, 16, v3
    v_mul_u32_u24 v4, 30, v3
    v_sub_u32 v4, v2, v4
    v_mul_u32_u24 v5, 205, v4
    v_lshrrev_b32 v5, 11, v5
    v_and_b32 v6, 0x33, v3
    v_and_b32 v7, 4, v3
    v_lshl_or_b32 v6, v7, 1, v6
    v_and_b32 v7, 8, v3
    v_lshrrev_b32 v7, 1, v7
    v_or_b32 v6, v7, v6
    v_mul_u32_u24 v6, 3840, v6
    v_mul_u32_u24 v5, 1120, v5
    v_lshl_add_u32 v6, v4, 4, v6
    v_add3_u32 v11, v6, v5, s46
    s_sub_u32 s46, s46, 1024
    v_add_u32 v2, s47, v254
    v_add_u32 v2, 128, v2
    v_mul_u32_u24 v3, 2185, v2
    v_lshrrev_b32 v3, 16, v3
    v_mul_u32_u24 v4, 30, v3
    v_sub_u32 v4, v2, v4
    v_mul_u32_u24 v5, 205, v4
    v_lshrrev_b32 v5, 11, v5
    v_and_b32 v6, 0x33, v3
    v_and_b32 v7, 4, v3
    v_lshl_or_b32 v6, v7, 1, v6
    v_and_b32 v7, 8, v3
    v_lshrrev_b32 v7, 1, v7
    v_or_b32 v6, v7, v6
    v_mul_u32_u24 v6, 3840, v6
    v_mul_u32_u24 v5, 1120, v5
    v_lshl_add_u32 v6, v4, 4, v6
    v_add3_u32 v12, v6, v5, s46
    s_sub_u32 s46, s46, 1024
    v_add_u32 v2, s47, v254
    v_add_u32 v2, 192, v2
    v_mul_u32_u24 v3, 2185, v2
    v_lshrrev_b32 v3, 16, v3
    v_mul_u32_u24 v4, 30, v3
    v_sub_u32 v4, v2, v4
    v_mul_u32_u24 v5, 205, v4
    v_lshrrev_b32 v5, 11, v5
    v_and_b32 v6, 0x33, v3
    v_and_b32 v7, 4, v3
    v_lshl_or_b32 v6, v7, 1, v6
    v_and_b32 v7, 8, v3
    v_lshrrev_b32 v7, 1, v7
    v_or_b32 v6, v7, v6
    v_mul_u32_u24 v6, 3840, v6
    v_mul_u32_u24 v5, 1120, v5
    v_lshl_add_u32 v6, v4, 4, v6
    v_add3_u32 v13, v6, v5, s46
    s_sub_u32 s46, s46, 1024
    s_cmp_eq_u32 s20, 3
    s_cselect_b32 s47, 0x40000000, 0
    v_or_b32 v13, s47, v13
    s_lshr_b32 s46, s20, 1
    s_add_u32 s46, s46, s23
    s_and_b32 s47, s20, 1
    s_lshl_b32 s47, s47, 6
    s_add_u32 s46, s46, s47
    s_mul_i32 s46, s46, 1280
    v_lshrrev_b32 v2, 3, v254
    v_mul_u32_u24 v2, 2560, v2
    v_lshrrev_b32 v3, 4, v254
    v_xor_b32 v3, v3, v254
    v_and_b32 v3, 7, v3
    v_lshl_add_u32 v2, v3, 4, v2
    v_xor_b32 v3, 64, v2
    v_add_u32 v3, 19456, v3
    v_add_u32 v14, s46, v2
    v_add_u32 v15, s46, v3
    v_add_u32 v16, 40960, v14
    v_add_u32 v17, 40960, v15
    s_waitcnt lgkmcnt(0)
    s_mov_b32 s24, s6
    s_mov_b32 s25, s7
    s_mov_b32 s26, 0x258000
    s_mov_b32 s27, 0x20000
    s_mov_b32 s28, s4
    s_mov_b32 s29, s5
    s_mov_b32 s30, 0x280000
    s_mov_b32 s31, 0x20000
    s_mov_b32 s42, 98304
    s_mul_i32 s43, s48, 245760
    s_mul_i32 s44, s48, 128
    s_mov_b32 s45, 0
QL_PRE:
    s_add_u32 m0, s42, s41
    s_add_u32 s46, s43, 122880
    buffer_load_dwordx4 v14, s[28:31], s44 offen offset:0 lds
    buffer_load_dwordx4 v15, s[28:31], s44 offen offset:1024 lds
    s_add_u32 m0, m0, 2048
    s_add_u32 s48, s48, 1
    buffer_load_dwordx4 v16, s[28:31], s44 offen offset:0 lds
    buffer_load_dwordx4 v17, s[28:31], s44 offen offset:1024 lds
    s_add_u32 m0, s42, s40
    s_add_u32 s44, s44, 128
    buffer_load_dwordx4 v10, s[24:27], s43 offen offset:0 lds
    buffer_load_dwordx4 v11, s[24:27], s43 offen offset:1024 lds
    buffer_load_dwordx4 v12, s[24:27], s43 offen offset:2048 lds
    buffer_load_dwordx4 v13, s[24:27], s43 offen offset:3072 lds
    s_add_u32 m0, m0, 16384
    s_add_u32 s43, s43, 245760
    buffer_load_dwordx4 v10, s[24:27], s46 offen offset:0 lds
    buffer_load_dwordx4 v11, s[24:27], s46 offen offset:1024 lds
    buffer_load_dwordx4 v12, s[24:27], s46 offen offset:2048 lds
    buffer_load_dwordx4 v13, s[24:27], s46 offen offset:3072 lds
    s_cmp_eq_u32 s48, 10
    s_cselect_b32 s43, 0, s43
    s_cselect_b32 s44, 0, s44
    s_add_u32 s42, s42, 49152
    s_cmp_eq_u32 s42, 147456
    s_cselect_b32 s42, 0, s42
    s_add_u32 s45, s45, 1
    s_branch P2S
QL_RET:
    s_add_u32 m0, s42, s41
    s_add_u32 s46, s43, 122880
    buffer_load_dwordx4 v14, s[28:31], s44 offen offset:0 lds
    buffer_load_dwordx4 v15, s[28:31], s44 offen offset:1024 lds
    s_add_u32 m0, m0, 2048
    s_add_u32 s48, s48, 1
    buffer_load_dwordx4 v16, s[28:31], s44 offen offset:0 lds
    buffer_load_dwordx4 v17, s[28:31], s44 offen offset:1024 lds
    s_add_u32 m0, s42, s40
    s_add_u32 s44, s44, 128
    buffer_load_dwordx4 v10, s[24:27], s43 offen offset:0 lds
    buffer_load_dwordx4 v11, s[24:27], s43 offen offset:1024 lds
    buffer_load_dwordx4 v12, s[24:27], s43 offen offset:2048 lds
    buffer_load_dwordx4 v13, s[24:27], s43 offen offset:3072 lds
    s_add_u32 m0, m0, 16384
    s_add_u32 s43, s43, 245760
    buffer_load_dwordx4 v10, s[24:27], s46 offen offset:0 lds
    buffer_load_dwordx4 v11, s[24:27], s46 offen offset:1024 lds
    buffer_load_dwordx4 v12, s[24:27], s46 offen offset:2048 lds
    buffer_load_dwordx4 v13, s[24:27], s46 offen offset:3072 lds
    s_cmp_eq_u32 s48, 10
    s_cselect_b32 s43, 0, s43
    s_cselect_b32 s44, 0, s44
    s_add_u32 s42, s42, 49152
    s_cmp_eq_u32 s42, 147456
    s_cselect_b32 s42, 0, s42
    s_add_u32 s45, s45, 1
QL_RL:
    s_waitcnt vmcnt(12)
    s_barrier
    s_add_u32 m0, s42, s41
    s_add_u32 s46, s43, 122880
    buffer_load_dwordx4 v14, s[28:31], s44 offen offset:0 lds
    buffer_load_dwordx4 v15, s[28:31], s44 offen offset:1024 lds
    s_add_u32 m0, m0, 2048
    s_add_u32 s48, s48, 1
    buffer_load_dwordx4 v16, s[28:31], s44 offen offset:0 lds
    buffer_load_dwordx4 v17, s[28:31], s44 offen offset:1024 lds
    s_add_u32 m0, s42, s40
    s_add_u32 s44, s44, 128
    buffer_load_dwordx4 v10, s[24:27], s43 offen offset:0 lds
    buffer_load_dwordx4 v11, s[24:27], s43 offen offset:1024 lds
    buffer_load_dwordx4 v12, s[24:27], s43 offen offset:2048 lds
    buffer_load_dwordx4 v13, s[24:27], s43 offen offset:3072 lds
    s_add_u32 m0, m0, 16384
    s_add_u32 s43, s43, 245760
    buffer_load_dwordx4 v10, s[24:27], s46 offen offset:0 lds
    buffer_load_dwordx4 v11, s[24:27], s46 offen offset:1024 lds
    buffer_load_dwordx4 v12, s[24:27], s46 offen offset:2048 lds
    buffer_load_dwordx4 v13, s[24:27], s46 offen offset:3072 lds
    s_cmp_eq_u32 s48, 10
    s_cselect_b32 s43, 0, s43
    s_cselect_b32 s44, 0, s44
    s_add_u32 s42, s42, 49152
    s_cmp_eq_u32 s42, 147456
    s_cselect_b32 s42, 0, s42
    s_add_u32 s45, s45, 1
    s_cmp_lt_u32 s45, 10
    s_cbranch_scc1 QL_RL
    s_branch P2L
QKV_C:
    s_lshr_b32 s40, s20, 1
    s_and_b32 s41, s20, 1
    v_mov_b32 v9, v254
    v_lshrrev_b32 v2, 4, v9
    v_and_b32 v3, 3, v9
    v_bfe_u32 v4, v9, 2, 3
    v_lshrrev_b32 v1, 5, v9
    v_lshl_add_u32 v4, v1, 4, v4
    s_mul_i32 s46, s41, 80
    v_mul_u32_u24 v4, 480, v4
    v_add_u32 v4, s46, v4
    v_lshl_add_u32 v224, v3, 3, v4
    v_and_b32 v5, 1, v3
    v_mul_u32_u24 v5, 40, v5
    v_lshrrev_b32 v6, 1, v3
    v_mul_u32_u24 v6, 160, v6
    v_add3_u32 v4, v4, v5, v6
    v_add_u32 v225, 32, v4
    s_lshl_b32 s46, s40, 13
    s_add_u32 s46, s46, 32768
    v_bfe_u32 v5, v9, 1, 3
    v_xor_b32 v5, v5, v2
    v_and_b32 v6, 15, v9
    v_lshlrev_b32 v6, 7, v6
    v_lshl_add_u32 v6, v5, 4, v6
    v_add_u32 v226, s46, v6
    v_xor_b32 v227, 64, v226
    v_and_b32 v3, 15, v9
    v_lshlrev_b32 v4, 2, v2
    v_sub_u32 v5, v3, v4
    s_cmp_eq_u32 s22, 0
    s_cselect_b32 s46, 7, 0
    v_subrev_u32 v4, s46, v4
    s_mov_b32 s47, 0xef800000
    v_subrev_u32 v6, 0, v5
    v_ashrrev_i32 v10, 31, v6
    v_sub_u32 v7, 7, v6
    v_ashrrev_i32 v7, 31, v7
    v_or_b32 v7, v7, v10
    v_and_b32 v232, s47, v7
    v_sub_u32 v8, -9, v6
    v_ashrrev_i32 v8, 31, v8
    v_and_b32 v236, s47, v8
    v_add_u32 v8, 0, v4
    v_ashrrev_i32 v8, 31, v8
    v_or_b32 v7, v7, v8
    v_and_b32 v240, s47, v7
    v_subrev_u32 v6, 1, v5
    v_ashrrev_i32 v11, 31, v6
    v_sub_u32 v7, 7, v6
    v_ashrrev_i32 v7, 31, v7
    v_or_b32 v7, v7, v11
    v_and_b32 v233, s47, v7
    v_sub_u32 v8, -9, v6
    v_ashrrev_i32 v8, 31, v8
    v_and_b32 v237, s47, v8
    v_add_u32 v8, 1, v4
    v_ashrrev_i32 v8, 31, v8
    v_or_b32 v7, v7, v8
    v_and_b32 v241, s47, v7
    v_subrev_u32 v6, 2, v5
    v_ashrrev_i32 v12, 31, v6
    v_sub_u32 v7, 7, v6
    v_ashrrev_i32 v7, 31, v7
    v_or_b32 v7, v7, v12
    v_and_b32 v234, s47, v7
    v_sub_u32 v8, -9, v6
    v_ashrrev_i32 v8, 31, v8
    v_and_b32 v238, s47, v8
    v_add_u32 v8, 2, v4
    v_ashrrev_i32 v8, 31, v8
    v_or_b32 v7, v7, v8
    v_and_b32 v242, s47, v7
    v_subrev_u32 v6, 3, v5
    v_ashrrev_i32 v13, 31, v6
    v_sub_u32 v7, 7, v6
    v_ashrrev_i32 v7, 31, v7
    v_or_b32 v7, v7, v13
    v_and_b32 v235, s47, v7
    v_sub_u32 v8, -9, v6
    v_ashrrev_i32 v8, 31, v8
    v_and_b32 v239, s47, v8
    v_add_u32 v8, 3, v4
    v_ashrrev_i32 v8, 31, v8
    v_or_b32 v7, v7, v8
    v_and_b32 v243, s47, v7
    s_mov_b32 s47, 0xffff
    v_bfi_b32 v244, s47, v10, v11
    v_bfi_b32 v245, s47, v12, v13
    v_add_u32 v6, -1, v2
    v_ashrrev_i32 v246, 31, v6
    v_xor_b32 v6, 1, v2
    v_add_u32 v6, -1, v6
    v_ashrrev_i32 v247, 31, v6
    v_add_u32 v6, -4, v3
    v_ashrrev_i32 v248, 31, v6
    v_xor_b32 v6, 4, v3
    v_add_u32 v6, -4, v6
    v_ashrrev_i32 v249, 31, v6
    s_mul_i32 s46, s22, 57
    s_add_u32 s46, s46, 9
    s_and_b32 s47, s46, 15
    v_add_u32 v6, s47, v3
    v_cmp_lt_u32 s[56:57], 15, v6
    v_and_b32 v6, 15, v6
    s_sub_u32 s46, s46, s47
    s_lshl_b32 s49, s22, 5
    s_add_u32 s46, s46, s49
    s_add_u32 s46, s46, 16
    v_add_u32 v7, s46, v6
    v_mul_u32_u24 v8, 12800, v2
    v_lshl_add_u32 v7, v7, 3, v8
    s_lshl_b32 s46, s21, 1
    s_add_u32 s46, s46, s41
    s_mul_i32 s49, s46, 102400
    s_mul_i32 s50, s40, 1638400
    s_add_u32 s49, s49, s50
    s_add_u32 s49, s49, 17825792
    v_lshl_add_u32 v251, v7, 1, s49
    s_mul_i32 s49, s46, 25600
    s_mul_i32 s50, s40, 409600
    s_add_u32 s49, s49, s50
    s_add_u32 s49, s49, 21102592
    v_lshlrev_b32 v8, 29, v2
    v_and_b32 v8, 0x40000000, v8
    v_add3_u32 v253, v7, v8, s49
    v_and_b32 v6, 8, v6
    v_subrev_u32 v6, s47, v6
    v_and_b32 v6, 0x40000000, v6
    v_add_u32 v7, -256, v251
    v_or_b32 v250, v6, v7
    v_xor_b32 v6, 0x40000000, v6
    v_or_b32 v254, v6, v251
    s_cmp_gt_u32 s47, 8
    s_cselect_b32 s46, 0x40000000, 0
    v_add_u32 v7, -128, v253
    v_or_b32 v252, s46, v7
    v_mov_b64 v[0:1], 0
    v_mov_b64 v[2:3], 0
    v_mov_b64 v[4:5], 0
    v_mov_b64 v[6:7], 0
    v_mov_b64 v[8:9], 0
    v_mov_b64 v[10:11], 0
    v_mov_b64 v[12:13], 0
    v_mov_b64 v[14:15], 0
    v_mov_b64 v[16:17], 0
    v_mov_b64 v[18:19], 0
    v_mov_b64 v[20:21], 0
    v_mov_b64 v[22:23], 0
    v_mov_b64 v[24:25], 0
    v_mov_b64 v[26:27], 0
    v_mov_b64 v[28:29], 0
    v_mov_b64 v[30:31], 0
    v_mov_b64 v[32:33], 0
    v_mov_b64 v[34:35], 0
    v_mov_b64 v[36:37], 0
    v_mov_b64 v[38:39], 0
    v_mov_b64 v[40:41], 0
    v_mov_b64 v[42:43], 0
    v_mov_b64 v[44:45], 0
    v_mov_b64 v[46:47], 0
    v_mov_b64 v[48:49], 0
    v_mov_b64 v[50:51], 0
    v_mov_b64 v[52:53], 0
    v_mov_b64 v[54:55], 0
    v_mov_b64 v[56:57], 0
    v_mov_b64 v[58:59], 0
    v_mov_b64 v[60:61], 0
    v_mov_b64 v[62:63], 0
    v_mov_b64 v[64:65], 0
    v_mov_b64 v[66:67], 0
    v_mov_b64 v[68:69], 0
    v_mov_b64 v[70:71], 0
    v_mov_b64 v[72:73], 0
    v_mov_b64 v[74:75], 0
    v_mov_b64 v[76:77], 0
    v_mov_b64 v[78:79], 0
    v_mov_b64 v[80:81], 0
    v_mov_b64 v[82:83], 0
    v_mov_b64 v[84:85], 0
    v_mov_b64 v[86:87], 0
    v_mov_b64 v[88:89], 0
    v_mov_b64 v[90:91], 0
    v_mov_b64 v[92:93], 0
    v_mov_b64 v[94:95], 0
    v_mov_b64 v[96:97], 0
    v_mov_b64 v[98:99], 0
    v_mov_b64 v[100:101], 0
    v_mov_b64 v[102:103], 0
    v_mov_b64 v[104:105], 0
    v_mov_b64 v[106:107], 0
    v_mov_b64 v[108:109], 0
    v_mov_b64 v[110:111], 0
    v_mov_b64 v[112:113], 0
    v_mov_b64 v[114:115], 0
    v_mov_b64 v[116:117], 0
    v_mov_b64 v[118:119], 0
    v_mov_b64 v[120:121], 0
    v_mov_b64 v[122:123], 0
    v_mov_b64 v[124:125], 0
    v_mov_b64 v[126:127], 0
    s_waitcnt lgkmcnt(0)
    s_mov_b32 s32, s18
    s_mov_b32 s33, s19
    s_mov_b32 s34, 0x1500000
    s_mov_b32 s35, 0x20000
    s_mov_b32 s50, 0x3ea52b5c
    s_mov_b32 s51, 0x3ea52b5c
    s_mov_b32 s52, 0xbea52b5c
    s_mov_b64 s[54:55], 0xffff
    s_lshl_b32 s67, s22, 8
    s_lshl_b32 s46, s21, 4
    s_add_u32 s67, s67, s46
    s_add_u32 s67, s67, 4096
    s_add_u32 s24, s18, 0xc10000
    s_addc_u32 s25, s19, 0
    s_mov_b32 s26, 0x4000
    s_mov_b32 s27, 0x20000
    s_mov_b32 s28, s62
    s_mov_b32 s29, s63
    s_mov_b32 s30, 0x100
    s_mov_b32 s31, 0x20000
    s_cmp_eq_u32 s20, 0
    s_cbranch_scc0 QA_SKIP
    s_mov_b64 exec, 1
    v_mov_b32 v255, 1
    buffer_store_dword v0, off, s[24:27], s67 sc1
    v_mov_b32 v128, 163824
    ds_write_b128 v128, v[0:3]
    s_waitcnt vmcnt(0) lgkmcnt(0)
    buffer_atomic_add v255, off, s[28:31], 0 sc1
    s_mov_b64 exec, -1
QA_SKIP:
    s_mov_b32 s42, 98304
    v_add_u32 v228, s42, v224
    v_add_u32 v229, s42, v225
    v_add_u32 v230, s42, v226
    v_add_u32 v231, s42, v227
    s_mov_b32 s45, 0
    s_barrier
    ds_read_b128 v[160:163], v230 offset:0
    ds_read_b128 v[164:167], v230 offset:2048
    ds_read_b128 v[168:171], v230 offset:4096
    ds_read_b128 v[172:175], v230 offset:6144
    ds_read_b64_tr_b16 v[128:129], v228 offset:0
    ds_read_b64_tr_b16 v[130:131], v228 offset:3840
    ds_read_b64_tr_b16 v[132:133], v228 offset:40
    ds_read_b64_tr_b16 v[134:135], v228 offset:3880
    ds_read_b64_tr_b16 v[136:137], v228 offset:160
    ds_read_b64_tr_b16 v[138:139], v228 offset:4000
    ds_read_b64_tr_b16 v[140:141], v228 offset:200
    ds_read_b64_tr_b16 v[142:143], v228 offset:4040
    ds_read_b64_tr_b16 v[144:145], v229 offset:0
    ds_read_b64_tr_b16 v[146:147], v229 offset:3840
    ds_read_b64_tr_b16 v[148:149], v228 offset:320
    ds_read_b64_tr_b16 v[150:151], v228 offset:4160
    ds_read_b64_tr_b16 v[152:153], v228 offset:360
    ds_read_b64_tr_b16 v[154:155], v228 offset:4200
    ds_read_b64_tr_b16 v[156:157], v229 offset:320
    ds_read_b64_tr_b16 v[158:159], v229 offset:4160
QC_LOOP:
    s_add_u32 s42, s42, 49152
    s_cmp_eq_u32 s42, 147456
    s_cselect_b32 s42, 0, s42
    s_add_u32 s45, s45, 1
    s_waitcnt lgkmcnt(0)
    v_mfma_f32_16x16x32_bf16 v[0:3], v[128:131], v[160:163], v[0:3]
    ds_read_b128 v[208:211], v231 offset:0
    v_mfma_f32_16x16x32_bf16 v[32:35], v[128:131], v[164:167], v[32:35]
    ds_read_b128 v[212:215], v231 offset:2048
    v_mfma_f32_16x16x32_bf16 v[64:67], v[128:131], v[168:171], v[64:67]
    ds_read_b128 v[216:219], v231 offset:4096
    v_mfma_f32_16x16x32_bf16 v[96:99], v[128:131], v[172:175], v[96:99]
    ds_read_b128 v[220:223], v231 offset:6144
    v_mfma_f32_16x16x32_bf16 v[4:7], v[132:135], v[160:163], v[4:7]
    ds_read_b64_tr_b16 v[176:177], v228 offset:16384
    v_mfma_f32_16x16x32_bf16 v[36:39], v[132:135], v[164:167], v[36:39]
    ds_read_b64_tr_b16 v[178:179], v228 offset:20224
    v_mfma_f32_16x16x32_bf16 v[68:71], v[132:135], v[168:171], v[68:71]
    ds_read_b64_tr_b16 v[180:181], v228 offset:16424
    v_mfma_f32_16x16x32_bf16 v[100:103], v[132:135], v[172:175], v[100:103]
    ds_read_b64_tr_b16 v[182:183], v228 offset:20264
    v_mfma_f32_16x16x32_bf16 v[8:11], v[136:139], v[160:163], v[8:11]
    ds_read_b64_tr_b16 v[184:185], v228 offset:16544
    v_mfma_f32_16x16x32_bf16 v[40:43], v[136:139], v[164:167], v[40:43]
    ds_read_b64_tr_b16 v[186:187], v228 offset:20384
    v_mfma_f32_16x16x32_bf16 v[72:75], v[136:139], v[168:171], v[72:75]
    ds_read_b64_tr_b16 v[188:189], v228 offset:16584
    v_mfma_f32_16x16x32_bf16 v[104:107], v[136:139], v[172:175], v[104:107]
    ds_read_b64_tr_b16 v[190:191], v228 offset:20424
    v_mfma_f32_16x16x32_bf16 v[12:15], v[140:143], v[160:163], v[12:15]
    ds_read_b64_tr_b16 v[192:193], v229 offset:16384
    v_mfma_f32_16x16x32_bf16 v[44:47], v[140:143], v[164:167], v[44:47]
    ds_read_b64_tr_b16 v[194:195], v229 offset:20224
    v_mfma_f32_16x16x32_bf16 v[76:79], v[140:143], v[168:171], v[76:79]
    ds_read_b64_tr_b16 v[196:197], v228 offset:16704
    v_mfma_f32_16x16x32_bf16 v[108:111], v[140:143], v[172:175], v[108:111]
    ds_read_b64_tr_b16 v[198:199], v228 offset:20544
    v_mfma_f32_16x16x32_bf16 v[16:19], v[144:147], v[160:163], v[16:19]
    ds_read_b64_tr_b16 v[200:201], v228 offset:16744
    v_mfma_f32_16x16x32_bf16 v[48:51], v[144:147], v[164:167], v[48:51]
    ds_read_b64_tr_b16 v[202:203], v228 offset:20584
    v_mfma_f32_16x16x32_bf16 v[80:83], v[144:147], v[168:171], v[80:83]
    ds_read_b64_tr_b16 v[204:205], v229 offset:16704
    v_mfma_f32_16x16x32_bf16 v[112:115], v[144:147], v[172:175], v[112:115]
    ds_read_b64_tr_b16 v[206:207], v229 offset:20544
    v_mfma_f32_16x16x32_bf16 v[20:23], v[160:163], v[148:151], v[20:23]
    v_add_u32 v228, s42, v224
    v_mfma_f32_16x16x32_bf16 v[52:55], v[164:167], v[148:151], v[52:55]
    v_add_u32 v229, s42, v225
    v_mfma_f32_16x16x32_bf16 v[84:87], v[168:171], v[148:151], v[84:87]
    v_add_u32 v230, s42, v226
    v_mfma_f32_16x16x32_bf16 v[116:119], v[172:175], v[148:151], v[116:119]
    v_add_u32 v231, s42, v227
    v_mfma_f32_16x16x32_bf16 v[24:27], v[160:163], v[152:155], v[24:27]
    v_mfma_f32_16x16x32_bf16 v[56:59], v[164:167], v[152:155], v[56:59]
    v_mfma_f32_16x16x32_bf16 v[88:91], v[168:171], v[152:155], v[88:91]
    v_mfma_f32_16x16x32_bf16 v[120:123], v[172:175], v[152:155], v[120:123]
    v_mfma_f32_16x16x32_bf16 v[28:31], v[160:163], v[156:159], v[28:31]
    v_mfma_f32_16x16x32_bf16 v[60:63], v[164:167], v[156:159], v[60:63]
    v_mfma_f32_16x16x32_bf16 v[92:95], v[168:171], v[156:159], v[92:95]
    v_mfma_f32_16x16x32_bf16 v[124:127], v[172:175], v[156:159], v[124:127]
    s_waitcnt lgkmcnt(0)
    s_barrier
    v_mfma_f32_16x16x32_bf16 v[0:3], v[176:179], v[208:211], v[0:3]
    ds_read_b128 v[160:163], v230 offset:0
    v_mfma_f32_16x16x32_bf16 v[32:35], v[176:179], v[212:215], v[32:35]
    ds_read_b128 v[164:167], v230 offset:2048
    v_mfma_f32_16x16x32_bf16 v[64:67], v[176:179], v[216:219], v[64:67]
    ds_read_b128 v[168:171], v230 offset:4096
    v_mfma_f32_16x16x32_bf16 v[96:99], v[176:179], v[220:223], v[96:99]
    ds_read_b128 v[172:175], v230 offset:6144
    v_mfma_f32_16x16x32_bf16 v[4:7], v[180:183], v[208:211], v[4:7]
    ds_read_b64_tr_b16 v[128:129], v228 offset:0
    v_mfma_f32_16x16x32_bf16 v[36:39], v[180:183], v[212:215], v[36:39]
    ds_read_b64_tr_b16 v[130:131], v228 offset:3840
    v_mfma_f32_16x16x32_bf16 v[68:71], v[180:183], v[216:219], v[68:71]
    ds_read_b64_tr_b16 v[132:133], v228 offset:40
    v_mfma_f32_16x16x32_bf16 v[100:103], v[180:183], v[220:223], v[100:103]
    ds_read_b64_tr_b16 v[134:135], v228 offset:3880
    v_mfma_f32_16x16x32_bf16 v[8:11], v[184:187], v[208:211], v[8:11]
    ds_read_b64_tr_b16 v[136:137], v228 offset:160
    v_mfma_f32_16x16x32_bf16 v[40:43], v[184:187], v[212:215], v[40:43]
    ds_read_b64_tr_b16 v[138:139], v228 offset:4000
    v_mfma_f32_16x16x32_bf16 v[72:75], v[184:187], v[216:219], v[72:75]
    ds_read_b64_tr_b16 v[140:141], v228 offset:200
    v_mfma_f32_16x16x32_bf16 v[104:107], v[184:187], v[220:223], v[104:107]
    ds_read_b64_tr_b16 v[142:143], v228 offset:4040
    v_mfma_f32_16x16x32_bf16 v[12:15], v[188:191], v[208:211], v[12:15]
    ds_read_b64_tr_b16 v[144:145], v229 offset:0
    v_mfma_f32_16x16x32_bf16 v[44:47], v[188:191], v[212:215], v[44:47]
    ds_read_b64_tr_b16 v[146:147], v229 offset:3840
    v_mfma_f32_16x16x32_bf16 v[76:79], v[188:191], v[216:219], v[76:79]
    ds_read_b64_tr_b16 v[148:149], v228 offset:320
    v_mfma_f32_16x16x32_bf16 v[108:111], v[188:191], v[220:223], v[108:111]
    ds_read_b64_tr_b16 v[150:151], v228 offset:4160
    v_mfma_f32_16x16x32_bf16 v[16:19], v[192:195], v[208:211], v[16:19]
    ds_read_b64_tr_b16 v[152:153], v228 offset:360
    v_mfma_f32_16x16x32_bf16 v[48:51], v[192:195], v[212:215], v[48:51]
    ds_read_b64_tr_b16 v[154:155], v228 offset:4200
    v_mfma_f32_16x16x32_bf16 v[80:83], v[192:195], v[216:219], v[80:83]
    ds_read_b64_tr_b16 v[156:157], v229 offset:320
    v_mfma_f32_16x16x32_bf16 v[112:115], v[192:195], v[220:223], v[112:115]
    ds_read_b64_tr_b16 v[158:159], v229 offset:4160
    v_mfma_f32_16x16x32_bf16 v[20:23], v[208:211], v[196:199], v[20:23]
    v_mfma_f32_16x16x32_bf16 v[52:55], v[212:215], v[196:199], v[52:55]
    v_mfma_f32_16x16x32_bf16 v[84:87], v[216:219], v[196:199], v[84:87]
    v_mfma_f32_16x16x32_bf16 v[116:119], v[220:223], v[196:199], v[116:119]
    v_mfma_f32_16x16x32_bf16 v[24:27], v[208:211], v[200:203], v[24:27]
    v_mfma_f32_16x16x32_bf16 v[56:59], v[212:215], v[200:203], v[56:59]
    v_mfma_f32_16x16x32_bf16 v[88:91], v[216:219], v[200:203], v[88:91]
    v_mfma_f32_16x16x32_bf16 v[120:123], v[220:223], v[200:203], v[120:123]
    v_mfma_f32_16x16x32_bf16 v[28:31], v[208:211], v[204:207], v[28:31]
    v_mfma_f32_16x16x32_bf16 v[60:63], v[212:215], v[204:207], v[60:63]
    v_mfma_f32_16x16x32_bf16 v[92:95], v[216:219], v[204:207], v[92:95]
    v_mfma_f32_16x16x32_bf16 v[124:127], v[220:223], v[204:207], v[124:127]
    s_cmp_lt_u32 s45, 10
    s_cbranch_scc1 QC_LOOP
    s_waitcnt lgkmcnt(0)
    s_nop 7
    v_mov_b32 v224, 0x3f803f80
    v_mov_b32 v225, 0x3f803f80
    v_mov_b32 v226, 0x3f803f80
    v_mov_b32 v227, 0x3f803f80
    v_cvt_pk_bf16_f32 v154, v16, v17
    v_cvt_pk_bf16_f32 v155, v18, v19
    v_cvt_pk_bf16_f32 v130, v16, v17
    v_cvt_pk_bf16_f32 v131, v18, v19
    v_cvt_pk_bf16_f32 v128, v8, v9
    v_cvt_pk_bf16_f32 v129, v10, v11
    v_cvt_pk_bf16_f32 v132, v12, v13
    v_cvt_pk_bf16_f32 v133, v14, v15
    v_cvt_pk_bf16_f32 v152, v0, v1
    v_cvt_pk_bf16_f32 v153, v2, v3
    v_cvt_pk_bf16_f32 v158, v4, v5
    v_cvt_pk_bf16_f32 v159, v6, v7
    v_permlane32_swap_b32 v154, v130
    v_permlane32_swap_b32 v155, v131
    v_and_b32 v156, v247, v154
    v_and_b32 v154, v246, v154
    v_and_b32 v157, v247, v155
    v_and_b32 v155, v246, v155
    v_cvt_pk_bf16_f32 v184, v20, v21
    v_cvt_pk_bf16_f32 v185, v22, v23
    v_cvt_pk_bf16_f32 v192, v24, v25
    v_cvt_pk_bf16_f32 v193, v26, v27
    v_cvt_pk_bf16_f32 v200, v28, v29
    v_cvt_pk_bf16_f32 v201, v30, v31
    v_and_b32 v208, v249, v200
    v_and_b32 v200, v248, v200
    v_and_b32 v209, v249, v201
    v_and_b32 v201, v248, v201
    v_cvt_pk_bf16_f32 v162, v48, v49
    v_cvt_pk_bf16_f32 v163, v50, v51
    v_cvt_pk_bf16_f32 v136, v48, v49
    v_cvt_pk_bf16_f32 v137, v50, v51
    v_cvt_pk_bf16_f32 v134, v40, v41
    v_cvt_pk_bf16_f32 v135, v42, v43
    v_cvt_pk_bf16_f32 v138, v44, v45
    v_cvt_pk_bf16_f32 v139, v46, v47
    v_cvt_pk_bf16_f32 v160, v32, v33
    v_cvt_pk_bf16_f32 v161, v34, v35
    v_cvt_pk_bf16_f32 v166, v36, v37
    v_cvt_pk_bf16_f32 v167, v38, v39
    v_permlane32_swap_b32 v162, v136
    v_permlane32_swap_b32 v163, v137
    v_and_b32 v164, v247, v162
    v_and_b32 v162, v246, v162
    v_and_b32 v165, v247, v163
    v_and_b32 v163, v246, v163
    v_cvt_pk_bf16_f32 v186, v52, v53
    v_cvt_pk_bf16_f32 v187, v54, v55
    v_cvt_pk_bf16_f32 v194, v56, v57
    v_cvt_pk_bf16_f32 v195, v58, v59
    v_cvt_pk_bf16_f32 v202, v60, v61
    v_cvt_pk_bf16_f32 v203, v62, v63
    v_and_b32 v210, v249, v202
    v_and_b32 v202, v248, v202
    v_and_b32 v211, v249, v203
    v_and_b32 v203, v248, v203
    v_mfma_f32_16x16x32_bf16 v[0:3], v[128:131], v[152:155], v[240:243]
    v_mfma_f32_16x16x32_bf16 v[12:15], v[130:133], v[156:159], v[240:243]
    v_cvt_pk_bf16_f32 v170, v80, v81
    v_cvt_pk_bf16_f32 v171, v82, v83
    v_cvt_pk_bf16_f32 v142, v80, v81
    v_cvt_pk_bf16_f32 v143, v82, v83
    v_cvt_pk_bf16_f32 v140, v72, v73
    v_cvt_pk_bf16_f32 v141, v74, v75
    v_cvt_pk_bf16_f32 v144, v76, v77
    v_cvt_pk_bf16_f32 v145, v78, v79
    v_cvt_pk_bf16_f32 v168, v64, v65
    v_cvt_pk_bf16_f32 v169, v66, v67
    v_cvt_pk_bf16_f32 v174, v68, v69
    v_cvt_pk_bf16_f32 v175, v70, v71
    v_permlane32_swap_b32 v170, v142
    v_permlane32_swap_b32 v171, v143
    v_and_b32 v172, v247, v170
    v_and_b32 v170, v246, v170
    v_and_b32 v173, v247, v171
    v_and_b32 v171, v246, v171
    v_cvt_pk_bf16_f32 v188, v84, v85
    v_cvt_pk_bf16_f32 v189, v86, v87
    v_cvt_pk_bf16_f32 v196, v88, v89
    v_cvt_pk_bf16_f32 v197, v90, v91
    v_cvt_pk_bf16_f32 v204, v92, v93
    v_cvt_pk_bf16_f32 v205, v94, v95
    v_and_b32 v212, v249, v204
    v_and_b32 v204, v248, v204
    v_and_b32 v213, v249, v205
    v_and_b32 v205, v248, v205
    v_mfma_f32_16x16x32_bf16 v[32:35], v[134:137], v[160:163], v[232:235]
    v_mfma_f32_16x16x32_bf16 v[36:39], v[128:131], v[160:163], v[236:239]
    v_mfma_f32_16x16x32_bf16 v[44:47], v[136:139], v[164:167], v[232:235]
    v_mfma_f32_16x16x32_bf16 v[48:51], v[130:133], v[164:167], v[236:239]
    v_cvt_pk_bf16_f32 v178, v112, v113
    v_cvt_pk_bf16_f32 v179, v114, v115
    v_cvt_pk_bf16_f32 v148, v112, v113
    v_cvt_pk_bf16_f32 v149, v114, v115
    v_cvt_pk_bf16_f32 v146, v104, v105
    v_cvt_pk_bf16_f32 v147, v106, v107
    v_cvt_pk_bf16_f32 v150, v108, v109
    v_cvt_pk_bf16_f32 v151, v110, v111
    v_cvt_pk_bf16_f32 v176, v96, v97
    v_cvt_pk_bf16_f32 v177, v98, v99
    v_cvt_pk_bf16_f32 v182, v100, v101
    v_cvt_pk_bf16_f32 v183, v102, v103
    v_permlane32_swap_b32 v178, v148
    v_permlane32_swap_b32 v179, v149
    v_and_b32 v180, v247, v178
    v_and_b32 v178, v246, v178
    v_and_b32 v181, v247, v179
    v_and_b32 v179, v246, v179
    v_cvt_pk_bf16_f32 v190, v116, v117
    v_cvt_pk_bf16_f32 v191, v118, v119
    v_cvt_pk_bf16_f32 v198, v120, v121
    v_cvt_pk_bf16_f32 v199, v122, v123
    v_cvt_pk_bf16_f32 v206, v124, v125
    v_cvt_pk_bf16_f32 v207, v126, v127
    v_and_b32 v214, v249, v206
    v_and_b32 v206, v248, v206
    v_and_b32 v215, v249, v207
    v_and_b32 v207, v248, v207
    v_mfma_f32_16x16x32_bf16 v[64:67], v[140:143], v[168:171], v[232:235]
    v_mfma_f32_16x16x32_bf16 v[68:71], v[134:137], v[168:171], v[236:239]
    v_mfma_f32_16x16x32_bf16 v[76:79], v[142:145], v[172:175], v[232:235]
    v_mfma_f32_16x16x32_bf16 v[80:83], v[136:139], v[172:175], v[236:239]
    v_mfma_f32_16x16x32_bf16 v[96:99], v[146:149], v[176:179], v[232:235]
    v_mfma_f32_16x16x32_bf16 v[100:103], v[140:143], v[176:179], v[236:239]
    v_mfma_f32_16x16x32_bf16 v[108:111], v[148:151], v[180:183], v[232:235]
    v_mfma_f32_16x16x32_bf16 v[112:115], v[142:145], v[180:183], v[236:239]
    v_max3_f32 v28, v0, v1, v2
    v_max_f32 v28, v28, v3
    v_max3_f32 v30, v12, v13, v14
    v_max_f32 v30, v30, v15
    v_max_f32 v32, v32, v36
    v_max_f32 v33, v33, v37
    v_max_f32 v34, v34, v38
    v_max_f32 v35, v35, v39
    v_max3_f32 v60, v32, v33, v34
    v_max_f32 v60, v60, v35
    v_max_f32 v44, v44, v48
    v_max_f32 v45, v45, v49
    v_max_f32 v46, v46, v50
    v_max_f32 v47, v47, v51
    v_max3_f32 v62, v44, v45, v46
    v_max_f32 v62, v62, v47
    v_permlane32_swap_b32 v28, v30
    v_max_f32 v28, v28, v30
    v_permlane32_swap_b32 v60, v62
    v_max_f32 v60, v60, v62
    v_max_f32 v64, v64, v68
    v_max_f32 v65, v65, v69
    v_permlane16_swap_b32 v28, v60
    v_max_f32 v28, v28, v60
    v_mul_f32 v60, s52, v28
    v_mul_f32 v28, s52, v28
    v_max_f32 v66, v66, v70
    v_max_f32 v67, v67, v71
    v_permlane16_swap_b32 v28, v60
    v_mov_b32 v30, v28
    v_mov_b32 v62, v60
    v_max3_f32 v92, v64, v65, v66
    v_permlane32_swap_b32 v28, v30
    v_permlane32_swap_b32 v60, v62
    v_max_f32 v92, v92, v67
    v_max_f32 v76, v76, v80
    v_max_f32 v77, v77, v81
    v_max_f32 v78, v78, v82
    v_max_f32 v79, v79, v83
    v_max3_f32 v94, v76, v77, v78
    v_max_f32 v94, v94, v79
    v_max_f32 v96, v96, v100
    v_max_f32 v97, v97, v101
    v_max_f32 v98, v98, v102
    v_max_f32 v99, v99, v103
    v_max3_f32 v124, v96, v97, v98
    v_max_f32 v124, v124, v99
    v_max_f32 v108, v108, v112
    v_max_f32 v109, v109, v113
    v_max_f32 v110, v110, v114
    v_max_f32 v111, v111, v115
    v_max3_f32 v126, v108, v109, v110
    v_max_f32 v126, v126, v111
    v_permlane32_swap_b32 v92, v94
    v_max_f32 v92, v92, v94
    v_permlane32_swap_b32 v124, v126
    v_max_f32 v124, v124, v126
    v_pk_fma_f32 v[0:1], v[0:1], s[50:51], v[28:29] op_sel:[0,0,0] op_sel_hi:[1,1,0]
    v_pk_fma_f32 v[2:3], v[2:3], s[50:51], v[28:29] op_sel:[0,0,0] op_sel_hi:[1,1,0]
    v_permlane16_swap_b32 v92, v124
    v_max_f32 v92, v92, v124
    v_mul_f32 v124, s52, v92
    v_mul_f32 v92, s52, v92
    v_exp_f32 v0, v0
    v_exp_f32 v1, v1
    v_permlane16_swap_b32 v92, v124
    v_mov_b32 v94, v92
    v_mov_b32 v126, v124
    v_exp_f32 v2, v2
    v_permlane32_swap_b32 v92, v94
    v_permlane32_swap_b32 v124, v126
    v_exp_f32 v3, v3
    v_cvt_pk_bf16_f32 v8, v0, v1
    v_cvt_pk_bf16_f32 v9, v2, v3
    v_mov_b64 v[10:11], 0
    v_pk_fma_f32 v[12:13], v[12:13], s[50:51], v[30:31] op_sel:[0,0,0] op_sel_hi:[1,1,0]
    v_pk_fma_f32 v[14:15], v[14:15], s[50:51], v[30:31] op_sel:[0,0,0] op_sel_hi:[1,1,0]
    v_exp_f32 v12, v12
    v_exp_f32 v13, v13
    v_exp_f32 v14, v14
    v_exp_f32 v15, v15
    v_cvt_pk_bf16_f32 v20, v12, v13
    v_cvt_pk_bf16_f32 v21, v14, v15
    v_mov_b64 v[22:23], 0
    v_mfma_f32_16x16x32_bf16 v[4:7], v[224:227], v[8:11], 0
    v_mfma_f32_16x16x32_bf16 v[0:3], v[184:187], v[8:11], 0
    v_mfma_f32_16x16x32_bf16 v[24:27], v[200:203], v[8:11], 0
    v_mfma_f32_16x16x32_bf16 v[16:19], v[224:227], v[20:23], 0
    v_mfma_f32_16x16x32_bf16 v[12:15], v[192:195], v[20:23], 0
    v_mfma_f32_16x16x32_bf16 v[24:27], v[208:211], v[20:23], v[24:27]
    v_pk_fma_f32 v[32:33], v[32:33], s[50:51], v[60:61] op_sel:[0,0,0] op_sel_hi:[1,1,0]
    v_pk_fma_f32 v[34:35], v[34:35], s[50:51], v[60:61] op_sel:[0,0,0] op_sel_hi:[1,1,0]
    v_exp_f32 v32, v32
    v_exp_f32 v33, v33
    v_exp_f32 v34, v34
    v_exp_f32 v35, v35
    v_cvt_pk_bf16_f32 v42, v32, v33
    v_cvt_pk_bf16_f32 v43, v34, v35
    v_and_b32 v40, v244, v42
    v_xor_b32 v42, v40, v42
    v_and_b32 v41, v245, v43
    v_xor_b32 v43, v41, v43
    v_pk_fma_f32 v[44:45], v[44:45], s[50:51], v[62:63] op_sel:[0,0,0] op_sel_hi:[1,1,0]
    v_pk_fma_f32 v[46:47], v[46:47], s[50:51], v[62:63] op_sel:[0,0,0] op_sel_hi:[1,1,0]
    v_exp_f32 v44, v44
    v_exp_f32 v45, v45
    v_exp_f32 v46, v46
    v_exp_f32 v47, v47
    v_cvt_pk_bf16_f32 v54, v44, v45
    v_cvt_pk_bf16_f32 v55, v46, v47
    v_and_b32 v52, v244, v54
    v_xor_b32 v54, v52, v54
    v_and_b32 v53, v245, v55
    v_xor_b32 v55, v53, v55
    v_mfma_f32_16x16x32_bf16 v[36:39], v[224:227], v[40:43], 0
    v_mfma_f32_16x16x32_bf16 v[32:35], v[184:187], v[40:43], 0
    v_mfma_f32_16x16x32_bf16 v[56:59], v[200:203], v[40:43], 0
    v_mfma_f32_16x16x32_bf16 v[48:51], v[224:227], v[52:55], 0
    v_mfma_f32_16x16x32_bf16 v[44:47], v[192:195], v[52:55], 0
    v_mfma_f32_16x16x32_bf16 v[56:59], v[208:211], v[52:55], v[56:59]
    v_rcp_f32 v4, v4
    v_rcp_f32 v16, v16
    v_pk_mul_f32 v[0:1], v[0:1], v[4:5] op_sel:[0,0] op_sel_hi:[1,0]
    v_pk_mul_f32 v[2:3], v[2:3], v[4:5] op_sel:[0,0] op_sel_hi:[1,0]
    v_cvt_pk_bf16_f32 v8, v0, v1
    v_cvt_pk_bf16_f32 v9, v2, v3
    v_pk_mul_f32 v[12:13], v[12:13], v[16:17] op_sel:[0,0] op_sel_hi:[1,0]
    v_pk_mul_f32 v[14:15], v[14:15], v[16:17] op_sel:[0,0] op_sel_hi:[1,0]
    v_cvt_pk_bf16_f32 v10, v12, v13
    v_cvt_pk_bf16_f32 v11, v14, v15
    v_cndmask_b32 v30, v16, v4, s[54:55]
    v_pk_mul_f32 v[24:25], v[24:25], v[30:31] op_sel:[0,0] op_sel_hi:[1,0]
    v_pk_mul_f32 v[26:27], v[26:27], v[30:31] op_sel:[0,0] op_sel_hi:[1,0]
    v_cvt_pk_bf16_f32 v24, v24, v25
    v_cvt_pk_bf16_f32 v25, v26, v27
    buffer_store_dwordx4 v[8:11], v250, s[32:35], 0 offen offset:0 sc1
    buffer_store_dwordx2 v[24:25], v252, s[32:35], 0 offen offset:0 sc1
    v_pk_fma_f32 v[64:65], v[64:65], s[50:51], v[92:93] op_sel:[0,0,0] op_sel_hi:[1,1,0]
    v_pk_fma_f32 v[66:67], v[66:67], s[50:51], v[92:93] op_sel:[0,0,0] op_sel_hi:[1,1,0]
    v_exp_f32 v64, v64
    v_exp_f32 v65, v65
    v_exp_f32 v66, v66
    v_exp_f32 v67, v67
    v_cvt_pk_bf16_f32 v74, v64, v65
    v_cvt_pk_bf16_f32 v75, v66, v67
    v_and_b32 v72, v244, v74
    v_xor_b32 v74, v72, v74
    v_and_b32 v73, v245, v75
    v_xor_b32 v75, v73, v75
    v_pk_fma_f32 v[76:77], v[76:77], s[50:51], v[94:95] op_sel:[0,0,0] op_sel_hi:[1,1,0]
    v_pk_fma_f32 v[78:79], v[78:79], s[50:51], v[94:95] op_sel:[0,0,0] op_sel_hi:[1,1,0]
    v_exp_f32 v76, v76
    v_exp_f32 v77, v77
    v_exp_f32 v78, v78
    v_exp_f32 v79, v79
    v_cvt_pk_bf16_f32 v86, v76, v77
    v_cvt_pk_bf16_f32 v87, v78, v79
    v_and_b32 v84, v244, v86
    v_xor_b32 v86, v84, v86
    v_and_b32 v85, v245, v87
    v_xor_b32 v87, v85, v87
    v_mfma_f32_16x16x32_bf16 v[68:71], v[224:227], v[72:75], 0
    v_mfma_f32_16x16x32_bf16 v[64:67], v[186:189], v[72:75], 0
    v_mfma_f32_16x16x32_bf16 v[88:91], v[202:205], v[72:75], 0
    v_mfma_f32_16x16x32_bf16 v[80:83], v[224:227], v[84:87], 0
    v_mfma_f32_16x16x32_bf16 v[76:79], v[194:197], v[84:87], 0
    v_mfma_f32_16x16x32_bf16 v[88:91], v[210:213], v[84:87], v[88:91]
    v_rcp_f32 v36, v36
    v_rcp_f32 v48, v48
    v_pk_mul_f32 v[32:33], v[32:33], v[36:37] op_sel:[0,0] op_sel_hi:[1,0]
    v_pk_mul_f32 v[34:35], v[34:35], v[36:37] op_sel:[0,0] op_sel_hi:[1,0]
    v_cvt_pk_bf16_f32 v40, v32, v33
    v_cvt_pk_bf16_f32 v41, v34, v35
    v_pk_mul_f32 v[44:45], v[44:45], v[48:49] op_sel:[0,0] op_sel_hi:[1,0]
    v_pk_mul_f32 v[46:47], v[46:47], v[48:49] op_sel:[0,0] op_sel_hi:[1,0]
    v_cvt_pk_bf16_f32 v42, v44, v45
    v_cvt_pk_bf16_f32 v43, v46, v47
    v_cndmask_b32 v62, v48, v36, s[54:55]
    v_pk_mul_f32 v[56:57], v[56:57], v[62:63] op_sel:[0,0] op_sel_hi:[1,0]
    v_pk_mul_f32 v[58:59], v[58:59], v[62:63] op_sel:[0,0] op_sel_hi:[1,0]
    v_cvt_pk_bf16_f32 v56, v56, v57
    v_cvt_pk_bf16_f32 v57, v58, v59
    v_cndmask_b32 v32, v40, v8, s[56:57]
    v_cndmask_b32 v33, v41, v9, s[56:57]
    v_cndmask_b32 v34, v42, v10, s[56:57]
    v_cndmask_b32 v35, v43, v11, s[56:57]
    v_cndmask_b32 v58, v56, v24, s[56:57]
    v_cndmask_b32 v59, v57, v25, s[56:57]
    buffer_store_dwordx4 v[32:35], v251, s[32:35], 0 offen offset:0 sc1
    buffer_store_dwordx2 v[58:59], v253, s[32:35], 0 offen offset:0 sc1
    v_pk_fma_f32 v[96:97], v[96:97], s[50:51], v[124:125] op_sel:[0,0,0] op_sel_hi:[1,1,0]
    v_pk_fma_f32 v[98:99], v[98:99], s[50:51], v[124:125] op_sel:[0,0,0] op_sel_hi:[1,1,0]
    v_exp_f32 v96, v96
    v_exp_f32 v97, v97
    v_exp_f32 v98, v98
    v_exp_f32 v99, v99
    v_cvt_pk_bf16_f32 v106, v96, v97
    v_cvt_pk_bf16_f32 v107, v98, v99
    v_and_b32 v104, v244, v106
    v_xor_b32 v106, v104, v106
    v_and_b32 v105, v245, v107
    v_xor_b32 v107, v105, v107
    v_pk_fma_f32 v[108:109], v[108:109], s[50:51], v[126:127] op_sel:[0,0,0] op_sel_hi:[1,1,0]
    v_pk_fma_f32 v[110:111], v[110:111], s[50:51], v[126:127] op_sel:[0,0,0] op_sel_hi:[1,1,0]
    v_exp_f32 v108, v108
    v_exp_f32 v109, v109
    v_exp_f32 v110, v110
    v_exp_f32 v111, v111
    v_cvt_pk_bf16_f32 v118, v108, v109
    v_cvt_pk_bf16_f32 v119, v110, v111
    v_and_b32 v116, v244, v118
    v_xor_b32 v118, v116, v118
    v_and_b32 v117, v245, v119
    v_xor_b32 v119, v117, v119
    v_mfma_f32_16x16x32_bf16 v[100:103], v[224:227], v[104:107], 0
    v_mfma_f32_16x16x32_bf16 v[96:99], v[188:191], v[104:107], 0
    v_mfma_f32_16x16x32_bf16 v[120:123], v[204:207], v[104:107], 0
    v_mfma_f32_16x16x32_bf16 v[112:115], v[224:227], v[116:119], 0
    v_mfma_f32_16x16x32_bf16 v[108:111], v[196:199], v[116:119], 0
    v_mfma_f32_16x16x32_bf16 v[120:123], v[212:215], v[116:119], v[120:123]
    v_rcp_f32 v68, v68
    v_rcp_f32 v80, v80
    v_pk_mul_f32 v[64:65], v[64:65], v[68:69] op_sel:[0,0] op_sel_hi:[1,0]
    v_pk_mul_f32 v[66:67], v[66:67], v[68:69] op_sel:[0,0] op_sel_hi:[1,0]
    v_cvt_pk_bf16_f32 v72, v64, v65
    v_cvt_pk_bf16_f32 v73, v66, v67
    v_pk_mul_f32 v[76:77], v[76:77], v[80:81] op_sel:[0,0] op_sel_hi:[1,0]
    v_pk_mul_f32 v[78:79], v[78:79], v[80:81] op_sel:[0,0] op_sel_hi:[1,0]
    v_cvt_pk_bf16_f32 v74, v76, v77
    v_cvt_pk_bf16_f32 v75, v78, v79
    v_cndmask_b32 v94, v80, v68, s[54:55]
    v_pk_mul_f32 v[88:89], v[88:89], v[94:95] op_sel:[0,0] op_sel_hi:[1,0]
    v_pk_mul_f32 v[90:91], v[90:91], v[94:95] op_sel:[0,0] op_sel_hi:[1,0]
    v_cvt_pk_bf16_f32 v88, v88, v89
    v_cvt_pk_bf16_f32 v89, v90, v91
    v_cndmask_b32 v64, v72, v40, s[56:57]
    v_cndmask_b32 v65, v73, v41, s[56:57]
    v_cndmask_b32 v66, v74, v42, s[56:57]
    v_cndmask_b32 v67, v75, v43, s[56:57]
    v_cndmask_b32 v90, v88, v56, s[56:57]
    v_cndmask_b32 v91, v89, v57, s[56:57]
    buffer_store_dwordx4 v[64:67], v251, s[32:35], 0 offen offset:256 sc1
    buffer_store_dwordx2 v[90:91], v253, s[32:35], 0 offen offset:128 sc1
    v_rcp_f32 v100, v100
    v_rcp_f32 v112, v112
    v_pk_mul_f32 v[96:97], v[96:97], v[100:101] op_sel:[0,0] op_sel_hi:[1,0]
    v_pk_mul_f32 v[98:99], v[98:99], v[100:101] op_sel:[0,0] op_sel_hi:[1,0]
    v_cvt_pk_bf16_f32 v104, v96, v97
    v_cvt_pk_bf16_f32 v105, v98, v99
    v_pk_mul_f32 v[108:109], v[108:109], v[112:113] op_sel:[0,0] op_sel_hi:[1,0]
    v_pk_mul_f32 v[110:111], v[110:111], v[112:113] op_sel:[0,0] op_sel_hi:[1,0]
    v_cvt_pk_bf16_f32 v106, v108, v109
    v_cvt_pk_bf16_f32 v107, v110, v111
    v_cndmask_b32 v126, v112, v100, s[54:55]
    v_pk_mul_f32 v[120:121], v[120:121], v[126:127] op_sel:[0,0] op_sel_hi:[1,0]
    v_pk_mul_f32 v[122:123], v[122:123], v[126:127] op_sel:[0,0] op_sel_hi:[1,0]
    v_cvt_pk_bf16_f32 v120, v120, v121
    v_cvt_pk_bf16_f32 v121, v122, v123
    v_cndmask_b32 v96, v104, v72, s[56:57]
    v_cndmask_b32 v97, v105, v73, s[56:57]
    v_cndmask_b32 v98, v106, v74, s[56:57]
    v_cndmask_b32 v99, v107, v75, s[56:57]
    v_cndmask_b32 v122, v120, v88, s[56:57]
    v_cndmask_b32 v123, v121, v89, s[56:57]
    buffer_store_dwordx4 v[96:99], v251, s[32:35], 0 offen offset:512 sc1
    buffer_store_dwordx2 v[122:123], v253, s[32:35], 0 offen offset:256 sc1
    buffer_store_dwordx4 v[104:107], v254, s[32:35], 0 offen offset:768 sc1
    buffer_store_dwordx2 v[120:121], v253, s[32:35], 0 offen offset:384 sc1
    s_branch P2C
K_FFN:
    s_mul_i32 s23, s21, 12
    s_add_u32 s23, s23, s22
    s_sub_u32 s23, s23, 18
    s_and_b32 s46, s21, 1
    s_lshr_b32 s21, s21, 1
    s_mul_i32 s23, s21, 12
    s_add_u32 s23, s23, s22
    s_sub_u32 s23, s23, 18
    s_lshr_b32 s21, s23, 3
    s_and_b32 s22, s23, 7
    s_lshl_b32 s46, s46, 3
    s_add_u32 s22, s22, s46
    s_add_u32 s48, s21, s22
    s_mul_i32 s49, s48, 256
    s_lshr_b32 s49, s49, 10
    s_mul_i32 s49, s49, 4
    s_sub_u32 s48, s48, s49
    s_cmp_lt_u32 s20, 4
    s_cbranch_scc1 FFN_C
    s_sub_u32 s20, s20, 4
    s_mul_i32 s40, s20, 4352
    s_lshl_b32 s41, s20, 12
    s_add_u32 s41, s41, 34816
    s_lshl_b32 s46, s21, 9
    s_lshl_b32 s47, s20, 3
    v_lshrrev_b32 v2, 5, v254
    v_and_b32 v3, 31, v254
    v_lshlrev_b32 v4, 1, v2
    v_xor_b32 v3, v3, v4
    v_add_u32 v2, s47, v2
    v_and_b32 v6, 0x33, v2
    v_and_b32 v7, 4, v2
    v_lshl_or_b32 v6, v7, 1, v6
    v_and_b32 v7, 8, v2
    v_lshrrev_b32 v7, 1, v7
    v_or_b32 v6, v7, v6
    v_mul_u32_u24 v6, 3072, v6
    v_lshl_add_u32 v6, v3, 4, v6
    v_add_u32 v10, s46, v6
    s_sub_u32 s46, s46, 1088
    v_add_u32 v2, 2, v2
    v_and_b32 v6, 0x33, v2
    v_and_b32 v7, 4, v2
    v_lshl_or_b32 v6, v7, 1, v6
    v_and_b32 v7, 8, v2
    v_lshrrev_b32 v7, 1, v7
    v_or_b32 v6, v7, v6
    v_mul_u32_u24 v6, 3072, v6
    v_lshl_add_u32 v6, v3, 4, v6
    v_add_u32 v11, s46, v6
    s_sub_u32 s46, s46, 1088
    v_add_u32 v2, 2, v2
    v_and_b32 v6, 0x33, v2
    v_and_b32 v7, 4, v2
    v_lshl_or_b32 v6, v7, 1, v6
    v_and_b32 v7, 8, v2
    v_lshrrev_b32 v7, 1, v7
    v_or_b32 v6, v7, v6
    v_mul_u32_u24 v6, 3072, v6
    v_lshl_add_u32 v6, v3, 4, v6
    v_add_u32 v12, s46, v6
    s_sub_u32 s46, s46, 1088
    v_add_u32 v2, 2, v2
    v_and_b32 v6, 0x33, v2
    v_and_b32 v7, 4, v2
    v_lshl_or_b32 v6, v7, 1, v6
    v_and_b32 v7, 8, v2
    v_lshrrev_b32 v7, 1, v7
    v_or_b32 v6, v7, v6
    v_mul_u32_u24 v6, 3072, v6
    v_lshl_add_u32 v6, v3, 4, v6
    v_add_u32 v13, s46, v6
    s_sub_u32 s46, s46, 1088
    v_add_u32 v2, 2, v2
    v_lshrrev_b32 v2, 3, v254
    v_mul_u32_u24 v2, 2560, v2
    v_lshrrev_b32 v3, 4, v254
    v_xor_b32 v3, v3, v254
    v_and_b32 v3, 7, v3
    v_lshl_add_u32 v2, v3, 4, v2
    v_xor_b32 v3, 64, v2
    v_add_u32 v3, 19456, v3
    s_lshl_b32 s46, s20, 1
    s_add_u32 s46, s46, s21
    s_and_b32 s47, s46, 1
    s_and_b32 s46, s46, 2
    s_lshl_b32 s46, s46, 4
    s_add_u32 s46, s46, s47
    s_lshr_b32 s47, s20, 1
    s_lshl_b32 s47, s47, 6
    s_add_u32 s46, s46, s47
    s_lshl_b32 s47, s22, 7
    s_add_u32 s46, s46, s47
    s_mul_i32 s46, s46, 1280
    v_add_u32 v14, s46, v2
    v_add_u32 v15, s46, v3
    s_lshl_b32 s46, s20, 1
    s_add_u32 s46, s46, s21
    s_add_u32 s46, s46, 1
    s_and_b32 s47, s46, 1
    s_and_b32 s46, s46, 2
    s_lshl_b32 s46, s46, 4
    s_add_u32 s46, s46, s47
    s_lshr_b32 s47, s20, 1
    s_lshl_b32 s47, s47, 6
    s_add_u32 s46, s46, s47
    s_lshl_b32 s47, s22, 7
    s_add_u32 s46, s46, s47
    s_mul_i32 s46, s46, 1280
    v_add_u32 v16, s46, v2
    v_add_u32 v17, s46, v3
    s_waitcnt lgkmcnt(0)
    s_mov_b32 s24, s12
    s_mov_b32 s25, s13
    s_mov_b32 s26, 0x1e0000
    s_mov_b32 s27, 0x20000
    s_mov_b32 s28, s4
    s_mov_b32 s29, s5
    s_mov_b32 s30, 0x280000
    s_mov_b32 s31, 0x20000
    s_mov_b32 s36, s16
    s_mov_b32 s37, s17
    s_mov_b32 s38, 0x500
    s_mov_b32 s39, 0x20000
    v_lshlrev_b32 v18, 4, v254
    s_mov_b32 s42, 102400
    s_mul_i32 s43, s48, 196608
    s_mul_i32 s44, s48, 128
    s_mov_b32 s45, 0
    s_mov_b32 m0, 153600
    s_nop 0
    buffer_load_dwordx4 v18, s[36:39], 0 offen lds
    buffer_load_dwordx4 v18, s[36:39], 0 offen offset:1024 lds
FL_PRE:
    s_add_u32 m0, s42, s41
    s_add_u32 s46, s43, 98304
    buffer_load_dwordx4 v14, s[28:31], s44 offen offset:0 lds
    buffer_load_dwordx4 v15, s[28:31], s44 offen offset:1024 lds
    s_add_u32 m0, m0, 2048
    s_add_u32 s48, s48, 1
    buffer_load_dwordx4 v16, s[28:31], s44 offen offset:0 lds
    buffer_load_dwordx4 v17, s[28:31], s44 offen offset:1024 lds
    s_add_u32 m0, s42, s40
    s_add_u32 s44, s44, 128
    buffer_load_dwordx4 v10, s[24:27], s43 offen offset:0 lds
    buffer_load_dwordx4 v11, s[24:27], s43 offen offset:1088 lds
    buffer_load_dwordx4 v12, s[24:27], s43 offen offset:2176 lds
    buffer_load_dwordx4 v13, s[24:27], s43 offen offset:3264 lds
    s_add_u32 m0, m0, 17408
    s_add_u32 s43, s43, 196608
    buffer_load_dwordx4 v10, s[24:27], s46 offen offset:0 lds
    buffer_load_dwordx4 v11, s[24:27], s46 offen offset:1088 lds
    buffer_load_dwordx4 v12, s[24:27], s46 offen offset:2176 lds
    buffer_load_dwordx4 v13, s[24:27], s46 offen offset:3264 lds
    s_cmp_eq_u32 s48, 10
    s_cselect_b32 s43, 0, s43
    s_cselect_b32 s44, 0, s44
    s_add_u32 s42, s42, 51200
    s_cmp_eq_u32 s42, 153600
    s_cselect_b32 s42, 0, s42
    s_add_u32 s45, s45, 1
    s_branch P2S
FL_RET:
    s_add_u32 m0, s42, s41
    s_add_u32 s46, s43, 98304
    buffer_load_dwordx4 v14, s[28:31], s44 offen offset:0 lds
    buffer_load_dwordx4 v15, s[28:31], s44 offen offset:1024 lds
    s_add_u32 m0, m0, 2048
    s_add_u32 s48, s48, 1
    buffer_load_dwordx4 v16, s[28:31], s44 offen offset:0 lds
    buffer_load_dwordx4 v17, s[28:31], s44 offen offset:1024 lds
    s_add_u32 m0, s42, s40
    s_add_u32 s44, s44, 128
    buffer_load_dwordx4 v10, s[24:27], s43 offen offset:0 lds
    buffer_load_dwordx4 v11, s[24:27], s43 offen offset:1088 lds
    buffer_load_dwordx4 v12, s[24:27], s43 offen offset:2176 lds
    buffer_load_dwordx4 v13, s[24:27], s43 offen offset:3264 lds
    s_add_u32 m0, m0, 17408
    s_add_u32 s43, s43, 196608
    buffer_load_dwordx4 v10, s[24:27], s46 offen offset:0 lds
    buffer_load_dwordx4 v11, s[24:27], s46 offen offset:1088 lds
    buffer_load_dwordx4 v12, s[24:27], s46 offen offset:2176 lds
    buffer_load_dwordx4 v13, s[24:27], s46 offen offset:3264 lds
    s_cmp_eq_u32 s48, 10
    s_cselect_b32 s43, 0, s43
    s_cselect_b32 s44, 0, s44
    s_add_u32 s42, s42, 51200
    s_cmp_eq_u32 s42, 153600
    s_cselect_b32 s42, 0, s42
    s_add_u32 s45, s45, 1
FL_RL:
    s_waitcnt vmcnt(12)
    s_barrier
    s_add_u32 m0, s42, s41
    s_add_u32 s46, s43, 98304
    buffer_load_dwordx4 v14, s[28:31], s44 offen offset:0 lds
    buffer_load_dwordx4 v15, s[28:31], s44 offen offset:1024 lds
    s_add_u32 m0, m0, 2048
    s_add_u32 s48, s48, 1
    buffer_load_dwordx4 v16, s[28:31], s44 offen offset:0 lds
    buffer_load_dwordx4 v17, s[28:31], s44 offen offset:1024 lds
    s_add_u32 m0, s42, s40
    s_add_u32 s44, s44, 128
    buffer_load_dwordx4 v10, s[24:27], s43 offen offset:0 lds
    buffer_load_dwordx4 v11, s[24:27], s43 offen offset:1088 lds
    buffer_load_dwordx4 v12, s[24:27], s43 offen offset:2176 lds
    buffer_load_dwordx4 v13, s[24:27], s43 offen offset:3264 lds
    s_add_u32 m0, m0, 17408
    s_add_u32 s43, s43, 196608
    buffer_load_dwordx4 v10, s[24:27], s46 offen offset:0 lds
    buffer_load_dwordx4 v11, s[24:27], s46 offen offset:1088 lds
    buffer_load_dwordx4 v12, s[24:27], s46 offen offset:2176 lds
    buffer_load_dwordx4 v13, s[24:27], s46 offen offset:3264 lds
    s_cmp_eq_u32 s48, 10
    s_cselect_b32 s43, 0, s43
    s_cselect_b32 s44, 0, s44
    s_add_u32 s42, s42, 51200
    s_cmp_eq_u32 s42, 153600
    s_cselect_b32 s42, 0, s42
    s_add_u32 s45, s45, 1
    s_cmp_lt_u32 s45, 10
    s_cbranch_scc1 FL_RL
    s_branch P2L
FFN_C:
    s_lshr_b32 s40, s20, 1
    s_and_b32 s41, s20, 1
    v_mov_b32 v9, v254
    v_lshrrev_b32 v2, 4, v9
    v_and_b32 v3, 3, v9
    v_bfe_u32 v4, v9, 2, 3
    v_lshrrev_b32 v1, 5, v9
    v_lshl_add_u32 v4, v1, 4, v4
    v_lshrrev_b32 v5, 1, v4
    v_mul_u32_u24 v5, 1088, v5
    v_and_b32 v4, 1, v4
    v_mul_u32_u24 v6, 544, v4
    v_lshl_add_u32 v5, v3, 3, v5
    s_lshl_b32 s46, s41, 8
    v_add3_u32 v236, v5, v6, s46
    v_lshlrev_b32 v4, 6, v4
    v_sub_u32 v237, v236, v4
    s_lshl_b32 s46, s40, 13
    s_add_u32 s46, s46, 34816
    v_lshlrev_b32 v244, 4, v9
    v_bfe_u32 v5, v9, 1, 3
    v_xor_b32 v5, v5, v2
    v_and_b32 v6, 15, v9
    v_lshlrev_b32 v6, 7, v6
    v_lshl_add_u32 v6, v5, 4, v6
    v_add_u32 v238, s46, v6
    v_xor_b32 v239, 64, v238
    v_lshlrev_b32 v5, 4, v2
    v_add_u32 v247, 153600, v5
    s_lshl_b32 s48, s48, 7
    v_add_u32 v246, s48, v247
    v_and_b32 v245, 31, v9
    s_lshr_b32 s46, s21, 2
    s_or_b32 s46, s46, s41
    s_lshl_b32 s46, s46, 30
    v_lshl_add_u32 v245, v245, 2, s46
    s_mov_b32 s56, 0xffff0000
    s_mov_b32 s57, 0xffff0000
    v_mov_b64 v[0:1], 0
    v_mov_b64 v[2:3], 0
    v_mov_b64 v[4:5], 0
    v_mov_b64 v[6:7], 0
    v_mov_b64 v[8:9], 0
    v_mov_b64 v[10:11], 0
    v_mov_b64 v[12:13], 0
    v_mov_b64 v[14:15], 0
    v_mov_b64 v[16:17], 0
    v_mov_b64 v[18:19], 0
    v_mov_b64 v[20:21], 0
    v_mov_b64 v[22:23], 0
    v_mov_b64 v[24:25], 0
    v_mov_b64 v[26:27], 0
    v_mov_b64 v[28:29], 0
    v_mov_b64 v[30:31], 0
    v_mov_b64 v[32:33], 0
    v_mov_b64 v[34:35], 0
    v_mov_b64 v[36:37], 0
    v_mov_b64 v[38:39], 0
    v_mov_b64 v[40:41], 0
    v_mov_b64 v[42:43], 0
    v_mov_b64 v[44:45], 0
    v_mov_b64 v[46:47], 0
    v_mov_b64 v[48:49], 0
    v_mov_b64 v[50:51], 0
    v_mov_b64 v[52:53], 0
    v_mov_b64 v[54:55], 0
    v_mov_b64 v[56:57], 0
    v_mov_b64 v[58:59], 0
    v_mov_b64 v[60:61], 0
    v_mov_b64 v[62:63], 0
    v_mov_b64 v[64:65], 0
    v_mov_b64 v[66:67], 0
    v_mov_b64 v[68:69], 0
    v_mov_b64 v[70:71], 0
    v_mov_b64 v[72:73], 0
    v_mov_b64 v[74:75], 0
    v_mov_b64 v[76:77], 0
    v_mov_b64 v[78:79], 0
    v_mov_b64 v[80:81], 0
    v_mov_b64 v[82:83], 0
    v_mov_b64 v[84:85], 0
    v_mov_b64 v[86:87], 0
    v_mov_b64 v[88:89], 0
    v_mov_b64 v[90:91], 0
    v_mov_b64 v[92:93], 0
    v_mov_b64 v[94:95], 0
    v_mov_b64 v[96:97], 0
    v_mov_b64 v[98:99], 0
    v_mov_b64 v[100:101], 0
    v_mov_b64 v[102:103], 0
    v_mov_b64 v[104:105], 0
    v_mov_b64 v[106:107], 0
    v_mov_b64 v[108:109], 0
    v_mov_b64 v[110:111], 0
    v_mov_b64 v[112:113], 0
    v_mov_b64 v[114:115], 0
    v_mov_b64 v[116:117], 0
    v_mov_b64 v[118:119], 0
    v_mov_b64 v[120:121], 0
    v_mov_b64 v[122:123], 0
    v_mov_b64 v[124:125], 0
    v_mov_b64 v[126:127], 0
    v_mov_b64 v[232:233], 0
    v_mov_b64 v[234:235], 0
    s_waitcnt lgkmcnt(0)
    s_mov_b32 s32, s18
    s_mov_b32 s33, s19
    s_mov_b32 s34, 0x880000
    s_mov_b32 s35, 0x20000
    s_add_u32 s36, s18, 0xc00000
    s_addc_u32 s37, s19, 0
    s_mov_b32 s38, 0x4000
    s_mov_b32 s39, 0x20000
    s_add_u32 s46, s21, 0
    s_and_b32 s46, s46, 3
    s_lshl_b32 s47, s40, 2
    s_add_u32 s46, s46, s47
    s_lshl_b32 s47, s22, 3
    s_add_u32 s46, s46, s47
    s_lshl_b32 s54, s46, 7
    s_mul_i32 s46, s46, 68
    s_lshl_b32 s47, s21, 3
    s_add_u32 s46, s46, s47
    s_lshl_b32 s47, s41, 2
    s_add_u32 s46, s46, s47
    s_add_u32 s46, s46, 20
    s_lshl_b32 s50, s46, 10
    s_add_u32 s46, s21, 1
    s_and_b32 s46, s46, 3
    s_lshl_b32 s47, s40, 2
    s_add_u32 s46, s46, s47
    s_lshl_b32 s47, s22, 3
    s_add_u32 s46, s46, s47
    s_mul_i32 s46, s46, 68
    s_lshl_b32 s47, s21, 3
    s_add_u32 s46, s46, s47
    s_lshl_b32 s47, s41, 2
    s_add_u32 s46, s46, s47
    s_add_u32 s46, s46, 20
    s_lshl_b32 s51, s46, 10
    s_add_u32 s46, s21, 2
    s_and_b32 s46, s46, 3
    s_lshl_b32 s47, s40, 2
    s_add_u32 s46, s46, s47
    s_lshl_b32 s47, s22, 3
    s_add_u32 s46, s46, s47
    s_mul_i32 s46, s46, 68
    s_lshl_b32 s47, s21, 3
    s_add_u32 s46, s46, s47
    s_lshl_b32 s47, s41, 2
    s_add_u32 s46, s46, s47
    s_add_u32 s46, s46, 20
    s_lshl_b32 s52, s46, 10
    s_add_u32 s46, s21, 3
    s_and_b32 s46, s46, 3
    s_lshl_b32 s47, s40, 2
    s_add_u32 s46, s46, s47
    s_lshl_b32 s47, s22, 3
    s_add_u32 s46, s46, s47
    s_mul_i32 s46, s46, 68
    s_lshl_b32 s47, s21, 3
    s_add_u32 s46, s46, s47
    s_lshl_b32 s47, s41, 2
    s_add_u32 s46, s46, s47
    s_add_u32 s46, s46, 20
    s_lshl_b32 s53, s46, 10
    s_lshl_b32 s67, s22, 8
    s_lshl_b32 s46, s21, 4
    s_add_u32 s67, s67, s46
    s_add_u32 s24, s18, 0xc10000
    s_addc_u32 s25, s19, 0
    s_mov_b32 s26, 0x4000
    s_mov_b32 s27, 0x20000
    s_mov_b32 s28, s62
    s_mov_b32 s29, s63
    s_mov_b32 s30, 0x100
    s_mov_b32 s31, 0x20000
    s_cmp_eq_u32 s20, 0
    s_cbranch_scc0 FA_SKIP
    s_mov_b64 exec, 1
    v_mov_b32 v255, 1
    buffer_store_dword v0, off, s[24:27], s67 sc1
    v_mov_b32 v128, 163824
    ds_write_b128 v128, v[0:3]
    s_waitcnt vmcnt(0) lgkmcnt(0)
    buffer_atomic_add v255, off, s[28:31], 0 sc1
    s_mov_b64 exec, -1
FA_SKIP:
    s_mov_b32 s42, 102400
    v_add_u32 v240, s42, v236
    v_add_u32 v241, s42, v237
    v_add_u32 v242, s42, v238
    v_add_u32 v243, s42, v239
    s_mov_b32 s45, 0
    s_barrier
    ds_read_b128 v[160:163], v242 offset:0
    ds_read_b128 v[164:167], v242 offset:2048
    ds_read_b128 v[168:171], v242 offset:4096
    ds_read_b128 v[172:175], v242 offset:6144
    ds_read_b128 v[176:179], v246 offset:0
    ds_read_b64_tr_b16 v[128:129], v240 offset:0
    ds_read_b64_tr_b16 v[130:131], v240 offset:4352
    ds_read_b64_tr_b16 v[132:133], v241 offset:32
    ds_read_b64_tr_b16 v[134:135], v241 offset:4384
    ds_read_b64_tr_b16 v[136:137], v240 offset:64
    ds_read_b64_tr_b16 v[138:139], v240 offset:4416
    ds_read_b64_tr_b16 v[140:141], v241 offset:96
    ds_read_b64_tr_b16 v[142:143], v241 offset:4448
    ds_read_b64_tr_b16 v[144:145], v240 offset:128
    ds_read_b64_tr_b16 v[146:147], v240 offset:4480
    ds_read_b64_tr_b16 v[148:149], v241 offset:160
    ds_read_b64_tr_b16 v[150:151], v241 offset:4512
    ds_read_b64_tr_b16 v[152:153], v240 offset:192
    ds_read_b64_tr_b16 v[154:155], v240 offset:4544
    ds_read_b64_tr_b16 v[156:157], v241 offset:224
    ds_read_b64_tr_b16 v[158:159], v241 offset:4576
FC_LOOP:
    s_add_u32 s42, s42, 51200
    s_cmp_eq_u32 s42, 153600
    s_cselect_b32 s42, 0, s42
    s_add_u32 s45, s45, 1
    s_add_u32 s48, s48, 128
    s_cmp_eq_u32 s48, 1280
    s_cselect_b32 s48, 0, s48
    s_waitcnt lgkmcnt(0)
    v_mfma_f32_16x16x32_bf16 v[232:235], v[176:179], v[160:163], v[232:235]
    ds_read_b128 v[212:215], v243 offset:0
    v_mfma_f32_16x16x32_bf16 v[0:3], v[128:131], v[160:163], v[0:3]
    ds_read_b128 v[216:219], v243 offset:2048
    v_mfma_f32_16x16x32_bf16 v[32:35], v[128:131], v[164:167], v[32:35]
    ds_read_b128 v[220:223], v243 offset:4096
    v_mfma_f32_16x16x32_bf16 v[64:67], v[128:131], v[168:171], v[64:67]
    ds_read_b128 v[224:227], v243 offset:6144
    v_mfma_f32_16x16x32_bf16 v[96:99], v[128:131], v[172:175], v[96:99]
    ds_read_b128 v[228:231], v246 offset:64
    v_mfma_f32_16x16x32_bf16 v[4:7], v[132:135], v[160:163], v[4:7]
    ds_read_b64_tr_b16 v[180:181], v240 offset:17408
    v_mfma_f32_16x16x32_bf16 v[36:39], v[132:135], v[164:167], v[36:39]
    ds_read_b64_tr_b16 v[182:183], v240 offset:21760
    v_mfma_f32_16x16x32_bf16 v[68:71], v[132:135], v[168:171], v[68:71]
    ds_read_b64_tr_b16 v[184:185], v241 offset:17440
    v_mfma_f32_16x16x32_bf16 v[100:103], v[132:135], v[172:175], v[100:103]
    ds_read_b64_tr_b16 v[186:187], v241 offset:21792
    v_mfma_f32_16x16x32_bf16 v[8:11], v[136:139], v[160:163], v[8:11]
    ds_read_b64_tr_b16 v[188:189], v240 offset:17472
    v_mfma_f32_16x16x32_bf16 v[40:43], v[136:139], v[164:167], v[40:43]
    ds_read_b64_tr_b16 v[190:191], v240 offset:21824
    v_mfma_f32_16x16x32_bf16 v[72:75], v[136:139], v[168:171], v[72:75]
    ds_read_b64_tr_b16 v[192:193], v241 offset:17504
    v_mfma_f32_16x16x32_bf16 v[104:107], v[136:139], v[172:175], v[104:107]
    ds_read_b64_tr_b16 v[194:195], v241 offset:21856
    v_mfma_f32_16x16x32_bf16 v[12:15], v[140:143], v[160:163], v[12:15]
    ds_read_b64_tr_b16 v[196:197], v240 offset:17536
    v_mfma_f32_16x16x32_bf16 v[44:47], v[140:143], v[164:167], v[44:47]
    ds_read_b64_tr_b16 v[198:199], v240 offset:21888
    v_mfma_f32_16x16x32_bf16 v[76:79], v[140:143], v[168:171], v[76:79]
    ds_read_b64_tr_b16 v[200:201], v241 offset:17568
    v_mfma_f32_16x16x32_bf16 v[108:111], v[140:143], v[172:175], v[108:111]
    ds_read_b64_tr_b16 v[202:203], v241 offset:21920
    v_mfma_f32_16x16x32_bf16 v[16:19], v[144:147], v[160:163], v[16:19]
    ds_read_b64_tr_b16 v[204:205], v240 offset:17600
    v_mfma_f32_16x16x32_bf16 v[48:51], v[144:147], v[164:167], v[48:51]
    ds_read_b64_tr_b16 v[206:207], v240 offset:21952
    v_mfma_f32_16x16x32_bf16 v[80:83], v[144:147], v[168:171], v[80:83]
    ds_read_b64_tr_b16 v[208:209], v241 offset:17632
    v_mfma_f32_16x16x32_bf16 v[112:115], v[144:147], v[172:175], v[112:115]
    ds_read_b64_tr_b16 v[210:211], v241 offset:21984
    v_mfma_f32_16x16x32_bf16 v[20:23], v[148:151], v[160:163], v[20:23]
    v_add_u32 v240, s42, v236
    v_mfma_f32_16x16x32_bf16 v[52:55], v[148:151], v[164:167], v[52:55]
    v_add_u32 v241, s42, v237
    v_mfma_f32_16x16x32_bf16 v[84:87], v[148:151], v[168:171], v[84:87]
    v_add_u32 v242, s42, v238
    v_mfma_f32_16x16x32_bf16 v[116:119], v[148:151], v[172:175], v[116:119]
    v_add_u32 v243, s42, v239
    v_mfma_f32_16x16x32_bf16 v[24:27], v[152:155], v[160:163], v[24:27]
    v_add_u32 v246, s48, v247
    v_mfma_f32_16x16x32_bf16 v[56:59], v[152:155], v[164:167], v[56:59]
    v_mfma_f32_16x16x32_bf16 v[88:91], v[152:155], v[168:171], v[88:91]
    v_mfma_f32_16x16x32_bf16 v[120:123], v[152:155], v[172:175], v[120:123]
    v_mfma_f32_16x16x32_bf16 v[28:31], v[156:159], v[160:163], v[28:31]
    v_mfma_f32_16x16x32_bf16 v[60:63], v[156:159], v[164:167], v[60:63]
    v_mfma_f32_16x16x32_bf16 v[92:95], v[156:159], v[168:171], v[92:95]
    v_mfma_f32_16x16x32_bf16 v[124:127], v[156:159], v[172:175], v[124:127]
    s_cmp_eq_u32 s45, 10
    s_waitcnt lgkmcnt(0)
    s_barrier
    s_cbranch_scc1 FC_TAIL
    v_mfma_f32_16x16x32_bf16 v[232:235], v[228:231], v[212:215], v[232:235]
    ds_read_b128 v[160:163], v242 offset:0
    v_mfma_f32_16x16x32_bf16 v[0:3], v[180:183], v[212:215], v[0:3]
    ds_read_b128 v[164:167], v242 offset:2048
    v_mfma_f32_16x16x32_bf16 v[32:35], v[180:183], v[216:219], v[32:35]
    ds_read_b128 v[168:171], v242 offset:4096
    v_mfma_f32_16x16x32_bf16 v[64:67], v[180:183], v[220:223], v[64:67]
    ds_read_b128 v[172:175], v242 offset:6144
    v_mfma_f32_16x16x32_bf16 v[96:99], v[180:183], v[224:227], v[96:99]
    ds_read_b128 v[176:179], v246 offset:0
    v_mfma_f32_16x16x32_bf16 v[4:7], v[184:187], v[212:215], v[4:7]
    ds_read_b64_tr_b16 v[128:129], v240 offset:0
    v_mfma_f32_16x16x32_bf16 v[36:39], v[184:187], v[216:219], v[36:39]
    ds_read_b64_tr_b16 v[130:131], v240 offset:4352
    v_mfma_f32_16x16x32_bf16 v[68:71], v[184:187], v[220:223], v[68:71]
    ds_read_b64_tr_b16 v[132:133], v241 offset:32
    v_mfma_f32_16x16x32_bf16 v[100:103], v[184:187], v[224:227], v[100:103]
    ds_read_b64_tr_b16 v[134:135], v241 offset:4384
    v_mfma_f32_16x16x32_bf16 v[8:11], v[188:191], v[212:215], v[8:11]
    ds_read_b64_tr_b16 v[136:137], v240 offset:64
    v_mfma_f32_16x16x32_bf16 v[40:43], v[188:191], v[216:219], v[40:43]
    ds_read_b64_tr_b16 v[138:139], v240 offset:4416
    v_mfma_f32_16x16x32_bf16 v[72:75], v[188:191], v[220:223], v[72:75]
    ds_read_b64_tr_b16 v[140:141], v241 offset:96
    v_mfma_f32_16x16x32_bf16 v[104:107], v[188:191], v[224:227], v[104:107]
    ds_read_b64_tr_b16 v[142:143], v241 offset:4448
    v_mfma_f32_16x16x32_bf16 v[12:15], v[192:195], v[212:215], v[12:15]
    ds_read_b64_tr_b16 v[144:145], v240 offset:128
    v_mfma_f32_16x16x32_bf16 v[44:47], v[192:195], v[216:219], v[44:47]
    ds_read_b64_tr_b16 v[146:147], v240 offset:4480
    v_mfma_f32_16x16x32_bf16 v[76:79], v[192:195], v[220:223], v[76:79]
    ds_read_b64_tr_b16 v[148:149], v241 offset:160
    v_mfma_f32_16x16x32_bf16 v[108:111], v[192:195], v[224:227], v[108:111]
    ds_read_b64_tr_b16 v[150:151], v241 offset:4512
    v_mfma_f32_16x16x32_bf16 v[16:19], v[196:199], v[212:215], v[16:19]
    ds_read_b64_tr_b16 v[152:153], v240 offset:192
    v_mfma_f32_16x16x32_bf16 v[48:51], v[196:199], v[216:219], v[48:51]
    ds_read_b64_tr_b16 v[154:155], v240 offset:4544
    v_mfma_f32_16x16x32_bf16 v[80:83], v[196:199], v[220:223], v[80:83]
    ds_read_b64_tr_b16 v[156:157], v241 offset:224
    v_mfma_f32_16x16x32_bf16 v[112:115], v[196:199], v[224:227], v[112:115]
    ds_read_b64_tr_b16 v[158:159], v241 offset:4576
    v_mfma_f32_16x16x32_bf16 v[20:23], v[200:203], v[212:215], v[20:23]
    v_mfma_f32_16x16x32_bf16 v[52:55], v[200:203], v[216:219], v[52:55]
    v_mfma_f32_16x16x32_bf16 v[84:87], v[200:203], v[220:223], v[84:87]
    v_mfma_f32_16x16x32_bf16 v[116:119], v[200:203], v[224:227], v[116:119]
    v_mfma_f32_16x16x32_bf16 v[24:27], v[204:207], v[212:215], v[24:27]
    v_mfma_f32_16x16x32_bf16 v[56:59], v[204:207], v[216:219], v[56:59]
    v_mfma_f32_16x16x32_bf16 v[88:91], v[204:207], v[220:223], v[88:91]
    v_mfma_f32_16x16x32_bf16 v[120:123], v[204:207], v[224:227], v[120:123]
    v_mfma_f32_16x16x32_bf16 v[28:31], v[208:211], v[212:215], v[28:31]
    v_mfma_f32_16x16x32_bf16 v[60:63], v[208:211], v[216:219], v[60:63]
    v_mfma_f32_16x16x32_bf16 v[92:95], v[208:211], v[220:223], v[92:95]
    v_mfma_f32_16x16x32_bf16 v[124:127], v[208:211], v[224:227], v[124:127]
    s_branch FC_LOOP
FC_TAIL:
    v_mfma_f32_16x16x32_bf16 v[0:3], v[180:183], v[212:215], v[0:3]
    v_mfma_f32_16x16x32_bf16 v[4:7], v[184:187], v[212:215], v[4:7]
    v_mfma_f32_16x16x32_bf16 v[8:11], v[188:191], v[212:215], v[8:11]
    v_mfma_f32_16x16x32_bf16 v[12:15], v[192:195], v[212:215], v[12:15]
    v_mfma_f32_16x16x32_bf16 v[232:235], v[228:231], v[212:215], v[232:235]
    v_mfma_f32_16x16x32_bf16 v[16:19], v[196:199], v[212:215], v[16:19]
    v_mfma_f32_16x16x32_bf16 v[20:23], v[200:203], v[212:215], v[20:23]
    v_mfma_f32_16x16x32_bf16 v[24:27], v[204:207], v[212:215], v[24:27]
    v_mfma_f32_16x16x32_bf16 v[28:31], v[208:211], v[212:215], v[28:31]
    v_cvt_pk_bf16_f32 v0, v0, v1
    v_cvt_pk_bf16_f32 v1, v2, v3
    v_cvt_pk_bf16_f32 v2, v4, v5
    v_cvt_pk_bf16_f32 v3, v6, v7
    v_pk_max_i16 v0, v0, 0
    v_pk_max_i16 v1, v1, 0
    v_pk_max_i16 v2, v2, 0
    v_pk_max_i16 v3, v3, 0
    buffer_store_dwordx4 v[0:3], v244, s[32:35], s50 offen offset:0 sc1
    v_cvt_pk_bf16_f32 v8, v8, v9
    v_cvt_pk_bf16_f32 v9, v10, v11
    v_cvt_pk_bf16_f32 v10, v12, v13
    v_cvt_pk_bf16_f32 v11, v14, v15
    v_pk_max_i16 v8, v8, 0
    v_pk_max_i16 v9, v9, 0
    v_pk_max_i16 v10, v10, 0
    v_pk_max_i16 v11, v11, 0
    buffer_store_dwordx4 v[8:11], v244, s[32:35], s50 offen offset:1024 sc1
    v_mfma_f32_16x16x32_bf16 v[32:35], v[180:183], v[216:219], v[32:35]
    v_cvt_pk_bf16_f32 v16, v16, v17
    v_cvt_pk_bf16_f32 v17, v18, v19
    v_cvt_pk_bf16_f32 v18, v20, v21
    v_cvt_pk_bf16_f32 v19, v22, v23
    v_mfma_f32_16x16x32_bf16 v[36:39], v[184:187], v[216:219], v[36:39]
    v_pk_max_i16 v16, v16, 0
    v_pk_max_i16 v17, v17, 0
    v_pk_max_i16 v18, v18, 0
    v_pk_max_i16 v19, v19, 0
    buffer_store_dwordx4 v[16:19], v244, s[32:35], s50 offen offset:2048 sc1
    v_mfma_f32_16x16x32_bf16 v[40:43], v[188:191], v[216:219], v[40:43]
    v_cvt_pk_bf16_f32 v24, v24, v25
    v_cvt_pk_bf16_f32 v25, v26, v27
    v_cvt_pk_bf16_f32 v26, v28, v29
    v_cvt_pk_bf16_f32 v27, v30, v31
    v_mfma_f32_16x16x32_bf16 v[44:47], v[192:195], v[216:219], v[44:47]
    v_pk_max_i16 v24, v24, 0
    v_pk_max_i16 v25, v25, 0
    v_pk_max_i16 v26, v26, 0
    v_pk_max_i16 v27, v27, 0
    buffer_store_dwordx4 v[24:27], v244, s[32:35], s50 offen offset:3072 sc1
    v_cvt_pk_bf16_f32 v232, v232, v232
    v_and_b32 v232, 0xffff0000, v232
    v_mul_f32 v232, 0xbfb8aa3b, v232
    v_exp_f32 v232, v232
    v_mfma_f32_16x16x32_bf16 v[48:51], v[196:199], v[216:219], v[48:51]
    v_add_f32 v232, 1.0, v232
    v_rcp_f32 v232, v232
    v_cvt_pk_bf16_f32 v32, v32, v33
    v_cvt_pk_bf16_f32 v232, v232, v232
    v_and_b32 v232, 0xffff0000, v232
    v_sub_f32 v233, 1.0, v232
    v_max_f32 v232, 0x21800000, v232
    v_cvt_pk_bf16_f32 v233, v233, v233
    v_rcp_f32 v234, v232
    v_and_b32 v233, 0xffff0000, v233
    v_mul_f32 v233, v233, v234
    v_cndmask_b32 v232, v232, v233, s[56:57]
    buffer_store_dword v232, v245, s[36:39], s54 offen sc1
    v_cvt_pk_bf16_f32 v33, v34, v35
    v_cvt_pk_bf16_f32 v34, v36, v37
    v_cvt_pk_bf16_f32 v35, v38, v39
    v_mfma_f32_16x16x32_bf16 v[52:55], v[200:203], v[216:219], v[52:55]
    v_pk_max_i16 v32, v32, 0
    v_pk_max_i16 v33, v33, 0
    v_pk_max_i16 v34, v34, 0
    v_pk_max_i16 v35, v35, 0
    buffer_store_dwordx4 v[32:35], v244, s[32:35], s51 offen offset:0 sc1
    v_mfma_f32_16x16x32_bf16 v[56:59], v[204:207], v[216:219], v[56:59]
    v_cvt_pk_bf16_f32 v40, v40, v41
    v_cvt_pk_bf16_f32 v41, v42, v43
    v_cvt_pk_bf16_f32 v42, v44, v45
    v_cvt_pk_bf16_f32 v43, v46, v47
    v_mfma_f32_16x16x32_bf16 v[60:63], v[208:211], v[216:219], v[60:63]
    v_pk_max_i16 v40, v40, 0
    v_pk_max_i16 v41, v41, 0
    v_pk_max_i16 v42, v42, 0
    v_pk_max_i16 v43, v43, 0
    buffer_store_dwordx4 v[40:43], v244, s[32:35], s51 offen offset:1024 sc1
    v_mfma_f32_16x16x32_bf16 v[64:67], v[180:183], v[220:223], v[64:67]
    v_cvt_pk_bf16_f32 v48, v48, v49
    v_cvt_pk_bf16_f32 v49, v50, v51
    v_cvt_pk_bf16_f32 v50, v52, v53
    v_cvt_pk_bf16_f32 v51, v54, v55
    v_mfma_f32_16x16x32_bf16 v[68:71], v[184:187], v[220:223], v[68:71]
    v_pk_max_i16 v48, v48, 0
    v_pk_max_i16 v49, v49, 0
    v_pk_max_i16 v50, v50, 0
    v_pk_max_i16 v51, v51, 0
    buffer_store_dwordx4 v[48:51], v244, s[32:35], s51 offen offset:2048 sc1
    v_mfma_f32_16x16x32_bf16 v[72:75], v[188:191], v[220:223], v[72:75]
    v_cvt_pk_bf16_f32 v56, v56, v57
    v_cvt_pk_bf16_f32 v57, v58, v59
    v_cvt_pk_bf16_f32 v58, v60, v61
    v_cvt_pk_bf16_f32 v59, v62, v63
    v_mfma_f32_16x16x32_bf16 v[76:79], v[192:195], v[220:223], v[76:79]
    v_pk_max_i16 v56, v56, 0
    v_pk_max_i16 v57, v57, 0
    v_pk_max_i16 v58, v58, 0
    v_pk_max_i16 v59, v59, 0
    buffer_store_dwordx4 v[56:59], v244, s[32:35], s51 offen offset:3072 sc1
    v_mfma_f32_16x16x32_bf16 v[80:83], v[196:199], v[220:223], v[80:83]
    v_cvt_pk_bf16_f32 v64, v64, v65
    v_cvt_pk_bf16_f32 v65, v66, v67
    v_cvt_pk_bf16_f32 v66, v68, v69
    v_cvt_pk_bf16_f32 v67, v70, v71
    v_mfma_f32_16x16x32_bf16 v[84:87], v[200:203], v[220:223], v[84:87]
    v_pk_max_i16 v64, v64, 0
    v_pk_max_i16 v65, v65, 0
    v_pk_max_i16 v66, v66, 0
    v_pk_max_i16 v67, v67, 0
    buffer_store_dwordx4 v[64:67], v244, s[32:35], s52 offen offset:0 sc1
    v_mfma_f32_16x16x32_bf16 v[88:91], v[204:207], v[220:223], v[88:91]
    v_cvt_pk_bf16_f32 v72, v72, v73
    v_cvt_pk_bf16_f32 v73, v74, v75
    v_cvt_pk_bf16_f32 v74, v76, v77
    v_cvt_pk_bf16_f32 v75, v78, v79
    v_mfma_f32_16x16x32_bf16 v[92:95], v[208:211], v[220:223], v[92:95]
    v_pk_max_i16 v72, v72, 0
    v_pk_max_i16 v73, v73, 0
    v_pk_max_i16 v74, v74, 0
    v_pk_max_i16 v75, v75, 0
    buffer_store_dwordx4 v[72:75], v244, s[32:35], s52 offen offset:1024 sc1
    v_mfma_f32_16x16x32_bf16 v[96:99], v[180:183], v[224:227], v[96:99]
    v_cvt_pk_bf16_f32 v80, v80, v81
    v_cvt_pk_bf16_f32 v81, v82, v83
    v_cvt_pk_bf16_f32 v82, v84, v85
    v_cvt_pk_bf16_f32 v83, v86, v87
    v_mfma_f32_16x16x32_bf16 v[100:103], v[184:187], v[224:227], v[100:103]
    v_pk_max_i16 v80, v80, 0
    v_pk_max_i16 v81, v81, 0
    v_pk_max_i16 v82, v82, 0
    v_pk_max_i16 v83, v83, 0
    buffer_store_dwordx4 v[80:83], v244, s[32:35], s52 offen offset:2048 sc1
    v_mfma_f32_16x16x32_bf16 v[104:107], v[188:191], v[224:227], v[104:107]
    v_cvt_pk_bf16_f32 v88, v88, v89
    v_cvt_pk_bf16_f32 v89, v90, v91
    v_cvt_pk_bf16_f32 v90, v92, v93
    v_cvt_pk_bf16_f32 v91, v94, v95
    v_mfma_f32_16x16x32_bf16 v[108:111], v[192:195], v[224:227], v[108:111]
    v_pk_max_i16 v88, v88, 0
    v_pk_max_i16 v89, v89, 0
    v_pk_max_i16 v90, v90, 0
    v_pk_max_i16 v91, v91, 0
    buffer_store_dwordx4 v[88:91], v244, s[32:35], s52 offen offset:3072 sc1
    v_mfma_f32_16x16x32_bf16 v[112:115], v[196:199], v[224:227], v[112:115]
    v_cvt_pk_bf16_f32 v96, v96, v97
    v_cvt_pk_bf16_f32 v97, v98, v99
    v_cvt_pk_bf16_f32 v98, v100, v101
    v_cvt_pk_bf16_f32 v99, v102, v103
    v_mfma_f32_16x16x32_bf16 v[116:119], v[200:203], v[224:227], v[116:119]
    v_pk_max_i16 v96, v96, 0
    v_pk_max_i16 v97, v97, 0
    v_pk_max_i16 v98, v98, 0
    v_pk_max_i16 v99, v99, 0
    buffer_store_dwordx4 v[96:99], v244, s[32:35], s53 offen offset:0 sc1
    v_mfma_f32_16x16x32_bf16 v[120:123], v[204:207], v[224:227], v[120:123]
    v_cvt_pk_bf16_f32 v104, v104, v105
    v_cvt_pk_bf16_f32 v105, v106, v107
    v_cvt_pk_bf16_f32 v106, v108, v109
    v_cvt_pk_bf16_f32 v107, v110, v111
    v_mfma_f32_16x16x32_bf16 v[124:127], v[208:211], v[224:227], v[124:127]
    v_pk_max_i16 v104, v104, 0
    v_pk_max_i16 v105, v105, 0
    v_pk_max_i16 v106, v106, 0
    v_pk_max_i16 v107, v107, 0
    buffer_store_dwordx4 v[104:107], v244, s[32:35], s53 offen offset:1024 sc1
    v_cvt_pk_bf16_f32 v112, v112, v113
    v_cvt_pk_bf16_f32 v113, v114, v115
    v_cvt_pk_bf16_f32 v114, v116, v117
    v_cvt_pk_bf16_f32 v115, v118, v119
    v_pk_max_i16 v112, v112, 0
    v_pk_max_i16 v113, v113, 0
    v_pk_max_i16 v114, v114, 0
    v_pk_max_i16 v115, v115, 0
    buffer_store_dwordx4 v[112:115], v244, s[32:35], s53 offen offset:2048 sc1
    v_cvt_pk_bf16_f32 v120, v120, v121
    v_cvt_pk_bf16_f32 v121, v122, v123
    v_cvt_pk_bf16_f32 v122, v124, v125
    v_cvt_pk_bf16_f32 v123, v126, v127
    v_pk_max_i16 v120, v120, 0
    v_pk_max_i16 v121, v121, 0
    v_pk_max_i16 v122, v122, 0
    v_pk_max_i16 v123, v123, 0
    buffer_store_dwordx4 v[120:123], v244, s[32:35], s53 offen offset:3072 sc1
    s_branch P2C
P2C:
    v_mov_b32 v255, 1
    v_mov_b32 v225, 163824
    s_mov_b64 exec, 1
    s_waitcnt vmcnt(0)
    ds_add_rtn_u32 v224, v225, v255
    s_waitcnt lgkmcnt(0)
    v_readfirstlane_b32 s59, v224
    s_cmp_eq_u32 s59, 3
    s_cbranch_scc0 PUB_SKIP
    buffer_store_dword v255, off, s[24:27], s67 sc1
PUB_SKIP:
    s_mov_b64 exec, -1
    s_lshr_b32 s46, s2, 3
    s_and_b32 s65, s2, 7
    s_lshl_b32 s65, s65, 4
    s_bitcmp1_b32 s2, 0
    s_mov_b32 s47, 0x33333
    s_cselect_b32 s47, 0x39999, s47
    s_mov_b32 s64, 0x1cccd
    s_cselect_b32 s64, 0x2666e, s64
    s_bitcmp1_b32 s2, 1
    s_cselect_b32 s47, s64, s47
    s_bfm_b32 s64, s46, 0
    s_and_b32 s64, s64, s47
    s_bcnt1_i32_b32 s64, s64
    s_sub_u32 s66, s46, s64
    s_bitcmp1_b32 s47, s46
    s_cselect_b32 s47, 1, 0
    s_lshr_b32 s46, s66, 1
    s_and_b32 s66, s66, 1
    s_mul_i32 s66, s66, 5
    s_add_u32 s66, s66, 6
    s_cmp_eq_u32 s47, 1
    s_cselect_b32 s64, s64, s46
    s_cselect_b32 s47, 0, s66
    s_cselect_b32 s66, 6, 5
    s_add_u32 s65, s65, s47
    s_mov_b32 s28, s60
    s_mov_b32 s29, s61
    s_mov_b32 s30, 0x280000
    s_mov_b32 s31, 0x20000
    s_add_u32 s36, s18, 0xc00000
    s_addc_u32 s37, s19, 0
    s_mov_b32 s38, 0x4000
    s_mov_b32 s39, 0x20000
    v_mbcnt_lo_u32_b32 v254, -1, 0
    v_mbcnt_hi_u32_b32 v254, -1, v254
    v_lshrrev_b32 v220, 3, v254
    v_and_b32 v221, 7, v254
    v_lshl_add_u32 v222, v221, 2, v220
    v_mul_u32_u24 v223, 2560, v220
    v_lshl_add_u32 v223, v221, 4, v223
    s_lshl_b32 s50, s64, 7
    s_mul_i32 s46, s20, 3
    s_lshr_b32 s47, s46, 1
    s_and_b32 s46, s46, 1
    s_lshl_b32 s46, s46, 3
    s_add_u32 s48, s47, 7
    s_sub_u32 s49, s47, 2
    s_cmp_lt_u32 s47, 2
    s_cselect_b32 s48, s48, s49
    s_lshl_b32 s48, s48, 14
    v_add_u32 v200, s46, v222
    v_and_b32 v200, 15, v200
    v_lshl_add_u32 v200, v200, 4, s48
    v_lshl_add_u32 v200, v221, 9, v200
    s_cmp_lt_u32 s47, s66
    s_cselect_b32 s51, 0, 0x40000000
    s_add_u32 s47, s47, s65
    s_lshl_b32 s48, s47, 5
    s_add_u32 s48, s48, s46
    s_lshl_b32 s48, s48, 2
    s_or_b32 s48, s48, s51
    v_lshl_add_u32 v208, v220, 2, s48
    s_lshr_b32 s48, s47, 1
    s_lshl_b32 s48, s48, 4
    s_add_u32 s48, s48, s46
    s_lshl_b32 s48, s48, 1
    s_and_b32 s47, s47, 1
    s_add_u32 s48, s48, s47
    s_mul_i32 s48, s48, 1280
    s_add_u32 s48, s48, s50
    s_or_b32 s48, s48, s51
    v_add_u32 v204, s48, v223
    s_mul_i32 s46, s20, 3
    s_add_u32 s46, s46, 1
    s_lshr_b32 s47, s46, 1
    s_and_b32 s46, s46, 1
    s_lshl_b32 s46, s46, 3
    s_add_u32 s48, s47, 7
    s_sub_u32 s49, s47, 2
    s_cmp_lt_u32 s47, 2
    s_cselect_b32 s48, s48, s49
    s_lshl_b32 s48, s48, 14
    v_add_u32 v201, s46, v222
    v_and_b32 v201, 15, v201
    v_lshl_add_u32 v201, v201, 4, s48
    v_lshl_add_u32 v201, v221, 9, v201
    s_cmp_lt_u32 s47, s66
    s_cselect_b32 s51, 0, 0x40000000
    s_add_u32 s47, s47, s65
    s_lshl_b32 s48, s47, 5
    s_add_u32 s48, s48, s46
    s_lshl_b32 s48, s48, 2
    s_or_b32 s48, s48, s51
    v_lshl_add_u32 v209, v220, 2, s48
    s_lshr_b32 s48, s47, 1
    s_lshl_b32 s48, s48, 4
    s_add_u32 s48, s48, s46
    s_lshl_b32 s48, s48, 1
    s_and_b32 s47, s47, 1
    s_add_u32 s48, s48, s47
    s_mul_i32 s48, s48, 1280
    s_add_u32 s48, s48, s50
    s_or_b32 s48, s48, s51
    v_add_u32 v205, s48, v223
    s_mul_i32 s46, s20, 3
    s_add_u32 s46, s46, 2
    s_lshr_b32 s47, s46, 1
    s_and_b32 s46, s46, 1
    s_lshl_b32 s46, s46, 3
    s_add_u32 s48, s47, 7
    s_sub_u32 s49, s47, 2
    s_cmp_lt_u32 s47, 2
    s_cselect_b32 s48, s48, s49
    s_lshl_b32 s48, s48, 14
    v_add_u32 v202, s46, v222
    v_and_b32 v202, 15, v202
    v_lshl_add_u32 v202, v202, 4, s48
    v_lshl_add_u32 v202, v221, 9, v202
    s_cmp_lt_u32 s47, s66
    s_cselect_b32 s51, 0, 0x40000000
    s_add_u32 s47, s47, s65
    s_lshl_b32 s48, s47, 5
    s_add_u32 s48, s48, s46
    s_lshl_b32 s48, s48, 2
    s_or_b32 s48, s48, s51
    v_lshl_add_u32 v210, v220, 2, s48
    s_lshr_b32 s48, s47, 1
    s_lshl_b32 s48, s48, 4
    s_add_u32 s48, s48, s46
    s_lshl_b32 s48, s48, 1
    s_and_b32 s47, s47, 1
    s_add_u32 s48, s48, s47
    s_mul_i32 s48, s48, 1280
    s_add_u32 s48, s48, s50
    s_or_b32 s48, s48, s51
    v_add_u32 v206, s48, v223
CH_SPIN:
    ds_read_b32 v224, v225 offset:4
    s_waitcnt lgkmcnt(0)
    v_cmp_eq_u32 vcc, 1, v224
    s_cbranch_vccz CH_SPIN
    buffer_load_dword v212, v208, s[36:39], 0 offen sc1
    buffer_load_dword v213, v209, s[36:39], 0 offen sc1
    buffer_load_dword v214, v210, s[36:39], 0 offen sc1
    s_cmp_eq_u32 s59, 3
    s_cbranch_scc0 OP_OK
    s_add_u32 s47, s65, s66
    s_sub_u32 s47, s47, 1
    s_lshr_b32 s54, s65, 1
    s_mul_i32 s54, s54, 18400
    s_lshr_b32 s54, s54, 16
    s_lshr_b32 s49, s47, 1
    s_mul_i32 s49, s49, 18400
    s_add_u32 s49, s49, 17250
    s_lshr_b32 s49, s49, 16
    s_sub_u32 s49, s49, s54
    s_lshl_b32 s54, s54, 8
    s_add_u32 s54, s54, 4096
    s_lshl_b32 s49, s49, 8
    v_and_b32 v226, 1, v220
    v_mul_u32_u24 v226, s49, v226
    v_lshl_add_u32 v226, v221, 4, v226
    s_mov_b64 exec, 0xffff
    s_mov_b32 s59, 0
OP_SPIN:
    buffer_load_dword v224, v226, s[24:27], s54 offen sc1
    s_add_u32 s59, s59, 1
    s_waitcnt vmcnt(0)
    v_cmp_ne_u32 vcc, 1, v224
    s_cbranch_vccz OP_SET
    s_cmp_lt_u32 s59, 20000
    s_cbranch_scc1 OP_SPIN
OP_SET:
    ds_write_b32 v225, v255 offset:8
    s_mov_b64 exec, -1
OP_OK:
    s_waitcnt lgkmcnt(0)
    s_waitcnt vmcnt(0)
    s_barrier
    ds_read_b128 v[0:3], v200 offset:0
    ds_read_b128 v[4:7], v200 offset:256
    ds_read_b128 v[8:11], v200 offset:4096
    ds_read_b128 v[12:15], v200 offset:4352
    ds_read_b128 v[16:19], v200 offset:8192
    ds_read_b128 v[20:23], v200 offset:8448
    ds_read_b128 v[24:27], v200 offset:12288
    ds_read_b128 v[28:31], v200 offset:12544
    ds_read_b128 v[32:35], v201 offset:0
    ds_read_b128 v[36:39], v201 offset:256
    ds_read_b128 v[40:43], v201 offset:4096
    ds_read_b128 v[44:47], v201 offset:4352
    ds_read_b128 v[48:51], v201 offset:8192
    ds_read_b128 v[52:55], v201 offset:8448
    ds_read_b128 v[56:59], v201 offset:12288
    ds_read_b128 v[60:63], v201 offset:12544
    ds_read_b128 v[64:67], v202 offset:0
    ds_read_b128 v[68:71], v202 offset:256
    ds_read_b128 v[72:75], v202 offset:4096
    ds_read_b128 v[76:79], v202 offset:4352
    ds_read_b128 v[80:83], v202 offset:8192
    ds_read_b128 v[84:87], v202 offset:8448
    ds_read_b128 v[88:91], v202 offset:12288
    ds_read_b128 v[92:95], v202 offset:12544
    s_waitcnt lgkmcnt(15)
    v_pk_add_f32 v[0:1], v[0:1], v[8:9]
    v_pk_add_f32 v[2:3], v[2:3], v[10:11]
    v_pk_add_f32 v[4:5], v[4:5], v[12:13]
    v_pk_add_f32 v[6:7], v[6:7], v[14:15]
    v_pk_add_f32 v[16:17], v[16:17], v[24:25]
    v_pk_add_f32 v[18:19], v[18:19], v[26:27]
    v_pk_add_f32 v[20:21], v[20:21], v[28:29]
    v_pk_add_f32 v[22:23], v[22:23], v[30:31]
    v_pk_add_f32 v[0:1], v[0:1], v[16:17]
    v_pk_add_f32 v[2:3], v[2:3], v[18:19]
    v_pk_add_f32 v[4:5], v[4:5], v[20:21]
    v_pk_add_f32 v[6:7], v[6:7], v[22:23]
    v_mul_f32 v0, v212, v0
    v_mul_f32 v1, v212, v1
    v_mul_f32 v2, v212, v2
    v_mul_f32 v3, v212, v3
    v_mul_f32 v4, v212, v4
    v_mul_f32 v5, v212, v5
    v_mul_f32 v6, v212, v6
    v_mul_f32 v7, v212, v7
    v_cvt_pk_bf16_f32 v8, v0, v1
    v_cvt_pk_bf16_f32 v9, v2, v3
    v_cvt_pk_bf16_f32 v10, v4, v5
    v_cvt_pk_bf16_f32 v11, v6, v7
    buffer_store_dwordx4 v[8:11], v204, s[28:31], 0 offen sc1
    s_waitcnt lgkmcnt(8)
    v_pk_add_f32 v[32:33], v[32:33], v[40:41]
    v_pk_add_f32 v[34:35], v[34:35], v[42:43]
    v_pk_add_f32 v[36:37], v[36:37], v[44:45]
    v_pk_add_f32 v[38:39], v[38:39], v[46:47]
    v_pk_add_f32 v[48:49], v[48:49], v[56:57]
    v_pk_add_f32 v[50:51], v[50:51], v[58:59]
    v_pk_add_f32 v[52:53], v[52:53], v[60:61]
    v_pk_add_f32 v[54:55], v[54:55], v[62:63]
    v_pk_add_f32 v[32:33], v[32:33], v[48:49]
    v_pk_add_f32 v[34:35], v[34:35], v[50:51]
    v_pk_add_f32 v[36:37], v[36:37], v[52:53]
    v_pk_add_f32 v[38:39], v[38:39], v[54:55]
    v_mul_f32 v32, v213, v32
    v_mul_f32 v33, v213, v33
    v_mul_f32 v34, v213, v34
    v_mul_f32 v35, v213, v35
    v_mul_f32 v36, v213, v36
    v_mul_f32 v37, v213, v37
    v_mul_f32 v38, v213, v38
    v_mul_f32 v39, v213, v39
    v_cvt_pk_bf16_f32 v40, v32, v33
    v_cvt_pk_bf16_f32 v41, v34, v35
    v_cvt_pk_bf16_f32 v42, v36, v37
    v_cvt_pk_bf16_f32 v43, v38, v39
    buffer_store_dwordx4 v[40:43], v205, s[28:31], 0 offen sc1
    s_waitcnt lgkmcnt(0)
    v_pk_add_f32 v[64:65], v[64:65], v[72:73]
    v_pk_add_f32 v[66:67], v[66:67], v[74:75]
    v_pk_add_f32 v[68:69], v[68:69], v[76:77]
    v_pk_add_f32 v[70:71], v[70:71], v[78:79]
    v_pk_add_f32 v[80:81], v[80:81], v[88:89]
    v_pk_add_f32 v[82:83], v[82:83], v[90:91]
    v_pk_add_f32 v[84:85], v[84:85], v[92:93]
    v_pk_add_f32 v[86:87], v[86:87], v[94:95]
    v_pk_add_f32 v[64:65], v[64:65], v[80:81]
    v_pk_add_f32 v[66:67], v[66:67], v[82:83]
    v_pk_add_f32 v[68:69], v[68:69], v[84:85]
    v_pk_add_f32 v[70:71], v[70:71], v[86:87]
    v_mul_f32 v64, v214, v64
    v_mul_f32 v65, v214, v65
    v_mul_f32 v66, v214, v66
    v_mul_f32 v67, v214, v67
    v_mul_f32 v68, v214, v68
    v_mul_f32 v69, v214, v69
    v_mul_f32 v70, v214, v70
    v_mul_f32 v71, v214, v71
    v_cvt_pk_bf16_f32 v72, v64, v65
    v_cvt_pk_bf16_f32 v73, v66, v67
    v_cvt_pk_bf16_f32 v74, v68, v69
    v_cvt_pk_bf16_f32 v75, v70, v71
    buffer_store_dwordx4 v[72:75], v206, s[28:31], 0 offen sc1
    s_endpgm
P2S:
    s_lshr_b32 s46, s2, 3
    s_and_b32 s65, s2, 7
    s_lshl_b32 s65, s65, 4
    s_bitcmp1_b32 s2, 0
    s_mov_b32 s47, 0x33333
    s_cselect_b32 s47, 0x39999, s47
    s_mov_b32 s64, 0x1cccd
    s_cselect_b32 s64, 0x2666e, s64
    s_bitcmp1_b32 s2, 1
    s_cselect_b32 s47, s64, s47
    s_bfm_b32 s64, s46, 0
    s_and_b32 s64, s64, s47
    s_bcnt1_i32_b32 s64, s64
    s_sub_u32 s66, s46, s64
    s_bitcmp1_b32 s47, s46
    s_cselect_b32 s47, 1, 0
    s_lshr_b32 s46, s66, 1
    s_and_b32 s66, s66, 1
    s_mul_i32 s66, s66, 5
    s_add_u32 s66, s66, 6
    s_cmp_eq_u32 s47, 1
    s_cselect_b32 s64, s64, s46
    s_cselect_b32 s47, 0, s66
    s_cselect_b32 s66, 6, 5
    s_add_u32 s65, s65, s47
    s_mov_b32 s88, s14
    s_mov_b32 s89, s15
    s_mov_b32 s90, 0x1e0000
    s_mov_b32 s91, 0x20000
    s_mov_b32 s92, s8
    s_mov_b32 s93, s9
    s_mov_b32 s94, 0xc8000
    s_mov_b32 s95, 0x20000
    s_mov_b32 s32, s18
    s_mov_b32 s33, s19
    s_mov_b32 s34, 0x1500000
    s_mov_b32 s35, 0x20000
    s_add_u32 s36, s18, 0xc10000
    s_addc_u32 s37, s19, 0
    s_mov_b32 s38, 0x4000
    s_mov_b32 s39, 0x20000
    s_mov_b32 s68, s62
    s_mov_b32 s69, s63
    s_mov_b32 s70, 0x100
    s_mov_b32 s71, 0x20000
    s_lshl_b32 s58, s20, 12
    s_lshl_b32 s46, s64, 7
    s_mul_i32 s55, s20, 491520
    s_add_u32 s55, s55, s46
    s_mul_i32 s56, s20, 204800
    s_add_u32 s56, s56, s46
    v_lshrrev_b32 v252, 3, v254
    v_and_b32 v253, 6, v252
    v_xor_b32 v253, v253, v254
    v_and_b32 v253, 7, v253
    v_mul_u32_u24 v238, 1280, v252
    v_lshl_add_u32 v238, v253, 4, v238
    v_lshrrev_b32 v252, 5, v254
    v_mul_u32_u24 v239, 20480, v252
    v_add_u32 v239, v239, v238
    s_mul_i32 s50, s20, 12288
    s_add_u32 s50, s50, 20480
    s_add_u32 s51, s50, 4096
    s_add_u32 s52, s50, 8192
    s_mul_i32 s6, s64, 1
    s_mul_i32 s7, s6, 171
    s_lshr_b32 s7, s7, 11
    s_mul_i32 s7, s7, 12
    s_sub_u32 s6, s6, s7
    s_mul_i32 s7, s6, 40960
    s_add_u32 s55, s55, s7
    s_sub_u32 s7, s55, 491520
    s_lshl_b32 s51, s6, 10
    s_add_u32 s50, s50, s51
    s_sub_u32 s51, s50, 12288
    s_and_b32 s46, s65, 1
    s_mul_i32 s10, s20, 409600
    s_add_u32 s10, s10, 17825792
    s_add_u32 s11, s10, 1638400
    s_mul_i32 s53, s20, 102400
    s_add_u32 s53, s53, 21102592
    s_add_u32 s57, s53, 409600
    s_mul_i32 s47, s46, 1638400
    s_add_u32 s10, s10, s47
    s_sub_u32 s11, s11, s47
    s_mul_i32 s47, s46, 409600
    s_add_u32 s53, s53, s47
    s_sub_u32 s57, s57, s47
    s_mul_i32 s46, s65, 69632
    v_lshl_add_u32 v232, v254, 4, s46
    v_add_u32 v233, 69632, v232
    v_add_u32 v234, 139264, v232
    v_add_u32 v235, 208896, v232
    v_add_u32 v236, 278528, v232
    v_add_u32 v237, 348160, v232
    s_cmp_eq_u32 s66, 5
    s_cselect_b32 s46, 0x40000000, 0
    s_cselect_b64 s[4:5], 0, -1
    v_or_b32 v237, s46, v237
    v_bfe_u32 v253, v254, 2, 3
    v_lshl_add_u32 v240, v252, 11, s58
    v_lshl_add_u32 v240, v253, 7, v240
    v_lshrrev_b32 v253, 1, v253
    v_lshl_add_u32 v240, v253, 5, v240
    v_and_b32 v253, 3, v254
    v_lshl_add_u32 v240, v253, 3, v240
    v_xor_b32 v241, 32, v240
    v_xor_b32 v242, 64, v240
    v_xor_b32 v243, 96, v240
    v_lshl_add_u32 v253, v252, 2, v254
    v_and_b32 v246, 48, v254
    v_lshl_add_u32 v246, v246, 4, s58
    v_add_u32 v248, 0, v253
    v_and_b32 v248, 15, v248
    v_lshl_add_u32 v248, v248, 4, v246
    v_add_u32 v249, 8, v253
    v_and_b32 v249, 15, v249
    v_lshl_add_u32 v249, v249, 4, v246
    v_add_u32 v250, 16, v253
    v_and_b32 v250, 15, v250
    v_lshl_add_u32 v250, v250, 4, v246
    v_add_u32 v251, 24, v253
    v_and_b32 v251, 15, v251
    v_lshl_add_u32 v251, v251, 4, v246
    s_add_u32 s47, s65, s66
    s_sub_u32 s47, s47, 1
    s_lshr_b32 s54, s65, 3
    s_lshr_b32 s49, s47, 3
    s_sub_u32 s49, s49, s54
    s_lshl_b32 s54, s54, 8
    s_lshl_b32 s49, s49, 8
    v_and_b32 v253, 31, v254
    v_lshlrev_b32 v253, 2, v253
    v_mad_u32_u24 v244, v252, s49, v253
    v_add_u32 v244, s54, v244
    v_lshrrev_b32 v253, 4, v254
    v_mul_u32_u24 v253, 25600, v253
    v_add_u32 v253, 256, v253
    v_and_b32 v254, 15, v254
    v_mov_b32 v245, 163824
    s_mov_b32 s98, 0x111111
    s_mov_b32 s99, 0x111111
    s_movk_i32 s97, 240
    s_cmp_lt_u32 s2, 144
    s_cbranch_scc1 QL_RET
    s_branch FL_RET
P2L:
    s_waitcnt vmcnt(12)
    s_barrier
    s_cmp_ge_u32 s6, 12
    s_cselect_b32 s47, s7, s55
    s_add_u32 m0, s58, 0
    s_add_u32 s46, s47, 0
    buffer_load_dwordx4 v238, s[88:91], s46 offen offset:0 lds
    s_add_u32 s46, s47, 19456
    buffer_load_dwordx4 v238, s[88:91], s46 offen offset:1024 lds
    s_add_u32 s46, s47, 8192
    buffer_load_dwordx4 v238, s[88:91], s46 offen offset:2048 lds
    s_add_u32 s46, s47, 27648
    buffer_load_dwordx4 v238, s[88:91], s46 offen offset:3072 lds
    s_cmp_ge_u32 s6, 11
    s_cselect_b32 s47, s7, s55
    s_add_u32 m0, s58, 16384
    s_add_u32 s46, s47, 40960
    buffer_load_dwordx4 v238, s[88:91], s46 offen offset:0 lds
    s_add_u32 s46, s47, 60416
    buffer_load_dwordx4 v238, s[88:91], s46 offen offset:1024 lds
    s_add_u32 s46, s47, 49152
    buffer_load_dwordx4 v238, s[88:91], s46 offen offset:2048 lds
    s_add_u32 s46, s47, 68608
    buffer_load_dwordx4 v238, s[88:91], s46 offen offset:3072 lds
    s_cmp_ge_u32 s6, 10
    s_cselect_b32 s47, s7, s55
    s_add_u32 m0, s58, 32768
    s_add_u32 s46, s47, 81920
    buffer_load_dwordx4 v238, s[88:91], s46 offen offset:0 lds
    s_add_u32 s46, s47, 101376
    buffer_load_dwordx4 v238, s[88:91], s46 offen offset:1024 lds
    s_add_u32 s46, s47, 90112
    buffer_load_dwordx4 v238, s[88:91], s46 offen offset:2048 lds
    s_add_u32 s46, s47, 109568
    buffer_load_dwordx4 v238, s[88:91], s46 offen offset:3072 lds
    s_waitcnt vmcnt(12)
    s_barrier
    buffer_load_dword v247, off, s[68:71], 0 sc1
    s_cmp_ge_u32 s6, 9
    s_cselect_b32 s47, s7, s55
    s_add_u32 m0, s58, 49152
    s_add_u32 s46, s47, 122880
    buffer_load_dwordx4 v238, s[88:91], s46 offen offset:0 lds
    s_add_u32 s46, s47, 142336
    buffer_load_dwordx4 v238, s[88:91], s46 offen offset:1024 lds
    s_add_u32 s46, s47, 131072
    buffer_load_dwordx4 v238, s[88:91], s46 offen offset:2048 lds
    s_add_u32 s46, s47, 150528
    buffer_load_dwordx4 v238, s[88:91], s46 offen offset:3072 lds
    s_cmp_ge_u32 s6, 8
    s_cselect_b32 s47, s7, s55
    s_add_u32 m0, s58, 65536
    s_add_u32 s46, s47, 163840
    buffer_load_dwordx4 v238, s[88:91], s46 offen offset:0 lds
    s_add_u32 s46, s47, 183296
    buffer_load_dwordx4 v238, s[88:91], s46 offen offset:1024 lds
    s_add_u32 s46, s47, 172032
    buffer_load_dwordx4 v238, s[88:91], s46 offen offset:2048 lds
    s_add_u32 s46, s47, 191488
    buffer_load_dwordx4 v238, s[88:91], s46 offen offset:3072 lds
    s_cmp_ge_u32 s6, 7
    s_cselect_b32 s47, s7, s55
    s_add_u32 m0, s58, 81920
    s_add_u32 s46, s47, 204800
    buffer_load_dwordx4 v238, s[88:91], s46 offen offset:0 lds
    s_add_u32 s46, s47, 224256
    buffer_load_dwordx4 v238, s[88:91], s46 offen offset:1024 lds
    s_add_u32 s46, s47, 212992
    buffer_load_dwordx4 v238, s[88:91], s46 offen offset:2048 lds
    s_add_u32 s46, s47, 232448
    buffer_load_dwordx4 v238, s[88:91], s46 offen offset:3072 lds
    s_barrier
    s_waitcnt vmcnt(21)
    ds_read_b64_tr_b16 v[96:97], v240 offset:0
    ds_read_b64_tr_b16 v[98:99], v240 offset:1024
    ds_read_b64_tr_b16 v[100:101], v241 offset:0
    ds_read_b64_tr_b16 v[102:103], v241 offset:1024
    ds_read_b64_tr_b16 v[104:105], v242 offset:0
    ds_read_b64_tr_b16 v[106:107], v242 offset:1024
    ds_read_b64_tr_b16 v[108:109], v243 offset:0
    ds_read_b64_tr_b16 v[110:111], v243 offset:1024
    s_waitcnt vmcnt(17)
    ds_read_b64_tr_b16 v[184:185], v240 offset:16384
    ds_read_b64_tr_b16 v[186:187], v240 offset:17408
    ds_read_b64_tr_b16 v[188:189], v241 offset:16384
    ds_read_b64_tr_b16 v[190:191], v241 offset:17408
    ds_read_b64_tr_b16 v[192:193], v242 offset:16384
    ds_read_b64_tr_b16 v[194:195], v242 offset:17408
    ds_read_b64_tr_b16 v[196:197], v243 offset:16384
    ds_read_b64_tr_b16 v[198:199], v243 offset:17408
    s_waitcnt vmcnt(13)
    ds_read_b64_tr_b16 v[200:201], v240 offset:32768
    ds_read_b64_tr_b16 v[202:203], v240 offset:33792
    ds_read_b64_tr_b16 v[204:205], v241 offset:32768
    ds_read_b64_tr_b16 v[206:207], v241 offset:33792
    ds_read_b64_tr_b16 v[208:209], v242 offset:32768
    ds_read_b64_tr_b16 v[210:211], v242 offset:33792
    ds_read_b64_tr_b16 v[212:213], v243 offset:32768
    ds_read_b64_tr_b16 v[214:215], v243 offset:33792
    s_waitcnt vmcnt(8)
    ds_read_b64_tr_b16 v[216:217], v240 offset:49152
    ds_read_b64_tr_b16 v[218:219], v240 offset:50176
    ds_read_b64_tr_b16 v[220:221], v241 offset:49152
    ds_read_b64_tr_b16 v[222:223], v241 offset:50176
    ds_read_b64_tr_b16 v[224:225], v242 offset:49152
    ds_read_b64_tr_b16 v[226:227], v242 offset:50176
    ds_read_b64_tr_b16 v[228:229], v243 offset:49152
    ds_read_b64_tr_b16 v[230:231], v243 offset:50176
    s_waitcnt lgkmcnt(0)
    s_cmp_lt_u32 s2, 144
    s_cbranch_scc1 GT_OK
GT_SPIN:
    ds_read_b32 v246, v245
    s_waitcnt lgkmcnt(0)
    v_cmp_ne_u32 vcc, 4, v246
    s_cbranch_vccnz GT_SPIN
GT_OK:
    s_cmp_ge_u32 s6, 6
    s_cselect_b32 s47, s7, s55
    s_add_u32 m0, s58, 98304
    s_add_u32 s46, s47, 245760
    buffer_load_dwordx4 v238, s[88:91], s46 offen offset:0 lds
    s_add_u32 s46, s47, 265216
    buffer_load_dwordx4 v238, s[88:91], s46 offen offset:1024 lds
    s_add_u32 s46, s47, 253952
    buffer_load_dwordx4 v238, s[88:91], s46 offen offset:2048 lds
    s_add_u32 s46, s47, 273408
    buffer_load_dwordx4 v238, s[88:91], s46 offen offset:3072 lds
    s_cmp_ge_u32 s6, 5
    s_cselect_b32 s47, s7, s55
    s_add_u32 m0, s58, 114688
    s_add_u32 s46, s47, 286720
    buffer_load_dwordx4 v238, s[88:91], s46 offen offset:0 lds
    s_add_u32 s46, s47, 306176
    buffer_load_dwordx4 v238, s[88:91], s46 offen offset:1024 lds
    s_add_u32 s46, s47, 294912
    buffer_load_dwordx4 v238, s[88:91], s46 offen offset:2048 lds
    s_add_u32 s46, s47, 314368
    buffer_load_dwordx4 v238, s[88:91], s46 offen offset:3072 lds
    s_cmp_ge_u32 s6, 4
    s_cselect_b32 s47, s7, s55
    s_add_u32 m0, s58, 131072
    s_add_u32 s46, s47, 327680
    buffer_load_dwordx4 v238, s[88:91], s46 offen offset:0 lds
    s_add_u32 s46, s47, 347136
    buffer_load_dwordx4 v238, s[88:91], s46 offen offset:1024 lds
    s_add_u32 s46, s47, 335872
    buffer_load_dwordx4 v238, s[88:91], s46 offen offset:2048 lds
    s_add_u32 s46, s47, 355328
    buffer_load_dwordx4 v238, s[88:91], s46 offen offset:3072 lds
    s_cmp_ge_u32 s6, 3
    s_cselect_b32 s47, s7, s55
    s_add_u32 m0, s58, 0
    s_add_u32 s46, s47, 368640
    buffer_load_dwordx4 v238, s[88:91], s46 offen offset:0 lds
    s_add_u32 s46, s47, 388096
    buffer_load_dwordx4 v238, s[88:91], s46 offen offset:1024 lds
    s_add_u32 s46, s47, 376832
    buffer_load_dwordx4 v238, s[88:91], s46 offen offset:2048 lds
    s_add_u32 s46, s47, 396288
    buffer_load_dwordx4 v238, s[88:91], s46 offen offset:3072 lds
    s_cmp_ge_u32 s6, 2
    s_cselect_b32 s47, s7, s55
    s_add_u32 m0, s58, 16384
    s_add_u32 s46, s47, 409600
    buffer_load_dwordx4 v238, s[88:91], s46 offen offset:0 lds
    s_add_u32 s46, s47, 429056
    buffer_load_dwordx4 v238, s[88:91], s46 offen offset:1024 lds
    s_add_u32 s46, s47, 417792
    buffer_load_dwordx4 v238, s[88:91], s46 offen offset:2048 lds
    s_add_u32 s46, s47, 437248
    buffer_load_dwordx4 v238, s[88:91], s46 offen offset:3072 lds
    s_cmp_ge_u32 s6, 1
    s_cselect_b32 s47, s7, s55
    s_add_u32 m0, s58, 32768
    s_add_u32 s46, s47, 450560
    buffer_load_dwordx4 v238, s[88:91], s46 offen offset:0 lds
    s_add_u32 s46, s47, 470016
    buffer_load_dwordx4 v238, s[88:91], s46 offen offset:1024 lds
    s_add_u32 s46, s47, 458752
    buffer_load_dwordx4 v238, s[88:91], s46 offen offset:2048 lds
    s_add_u32 s46, s47, 478208
    buffer_load_dwordx4 v238, s[88:91], s46 offen offset:3072 lds
    s_add_u32 m0, s58, 49152
    s_add_u32 s46, s56, 0
    buffer_load_dwordx4 v238, s[92:95], s46 offen offset:0 lds
    s_add_u32 s46, s56, 24576
    buffer_load_dwordx4 v238, s[92:95], s46 offen offset:1024 lds
    s_add_u32 s46, s56, 8192
    buffer_load_dwordx4 v238, s[92:95], s46 offen offset:2048 lds
    s_add_u32 s46, s56, 32768
    buffer_load_dwordx4 v238, s[92:95], s46 offen offset:3072 lds
    s_cmp_eq_u32 s20, 0
    s_cbranch_scc0 LH_SPIN
    v_mov_b32 v246, 0
    v_cmp_ne_u32 s[48:49], s97, v247
    s_and_b64 s[48:49], s[48:49], exec
    s_cbranch_scc0 CK_OK
    s_mov_b32 s59, 0
CK_SPIN:
    buffer_load_dword v247, off, s[68:71], 0 sc1
    s_add_u32 s59, s59, 1
    s_waitcnt vmcnt(0)
    v_cmp_ne_u32 s[48:49], s97, v247
    s_and_b64 s[48:49], s[48:49], exec
    s_cbranch_scc0 CK_OK
    s_cmp_lt_u32 s59, 20000
    s_cbranch_scc1 CK_SPIN
CK_OK:
    v_cmp_ne_u32 s[48:49], 1, v246
    s_and_b64 s[48:49], s[48:49], s[98:99]
    s_cbranch_scc0 PH_OK
    s_mov_b32 s59, 0
PH_SPIN:
    buffer_load_dword v246, v244, s[36:39], 0 offen sc1
    s_add_u32 s59, s59, 1
    s_waitcnt vmcnt(0)
    v_cmp_ne_u32 s[48:49], 1, v246
    s_and_b64 s[48:49], s[48:49], s[98:99]
    s_cbranch_scc0 PH_OK
    s_cmp_lt_u32 s59, 20000
    s_cbranch_scc1 PH_SPIN
PH_OK:
    v_mov_b32 v246, 1
    ds_write_b32 v245, v246 offset:4
    s_branch LH_OK
LH_SPIN:
    ds_read_b32 v246, v245 offset:4
    s_waitcnt lgkmcnt(0)
    v_cmp_ne_u32 vcc, 0, v246
    s_cbranch_vccz LH_SPIN
LH_OK:
    s_cmp_ge_u32 s6, 12
    s_cselect_b32 s52, s51, s50
    s_add_u32 s52, s52, 0
    buffer_load_dwordx4 v[112:115], v232, s[32:35], s52 offen offset:0 sc1
    buffer_load_dwordx4 v[116:119], v233, s[32:35], s52 offen offset:0 sc1
    buffer_load_dwordx4 v[120:123], v234, s[32:35], s52 offen offset:0 sc1
    buffer_load_dwordx4 v[124:127], v235, s[32:35], s52 offen offset:0 sc1
    buffer_load_dwordx4 v[128:131], v236, s[32:35], s52 offen offset:0 sc1
    s_mov_b64 exec, s[4:5]
    buffer_load_dwordx4 v[132:135], v237, s[32:35], s52 offen offset:0 sc1
    s_mov_b64 exec, -1
    s_cmp_ge_u32 s6, 11
    s_cselect_b32 s52, s51, s50
    s_add_u32 s52, s52, 1024
    buffer_load_dwordx4 v[136:139], v232, s[32:35], s52 offen offset:0 sc1
    buffer_load_dwordx4 v[140:143], v233, s[32:35], s52 offen offset:0 sc1
    buffer_load_dwordx4 v[144:147], v234, s[32:35], s52 offen offset:0 sc1
    buffer_load_dwordx4 v[148:151], v235, s[32:35], s52 offen offset:0 sc1
    buffer_load_dwordx4 v[152:155], v236, s[32:35], s52 offen offset:0 sc1
    s_mov_b64 exec, s[4:5]
    buffer_load_dwordx4 v[156:159], v237, s[32:35], s52 offen offset:0 sc1
    s_mov_b64 exec, -1
    s_cmp_ge_u32 s6, 10
    s_cselect_b32 s52, s51, s50
    s_add_u32 s52, s52, 2048
    buffer_load_dwordx4 v[160:163], v232, s[32:35], s52 offen offset:0 sc1
    buffer_load_dwordx4 v[164:167], v233, s[32:35], s52 offen offset:0 sc1
    buffer_load_dwordx4 v[168:171], v234, s[32:35], s52 offen offset:0 sc1
    buffer_load_dwordx4 v[172:175], v235, s[32:35], s52 offen offset:0 sc1
    buffer_load_dwordx4 v[176:179], v236, s[32:35], s52 offen offset:0 sc1
    s_mov_b64 exec, s[4:5]
    buffer_load_dwordx4 v[180:183], v237, s[32:35], s52 offen offset:0 sc1
    s_mov_b64 exec, -1
    s_waitcnt vmcnt(12)
    v_mfma_f32_16x16x32_bf16 v[0:3], v[96:99], v[112:115], 0
    v_mfma_f32_16x16x32_bf16 v[16:19], v[96:99], v[116:119], 0
    v_mfma_f32_16x16x32_bf16 v[32:35], v[96:99], v[120:123], 0
    v_mfma_f32_16x16x32_bf16 v[48:51], v[96:99], v[124:127], 0
    v_mfma_f32_16x16x32_bf16 v[64:67], v[96:99], v[128:131], 0
    v_mfma_f32_16x16x32_bf16 v[80:83], v[96:99], v[132:135], 0
    v_mfma_f32_16x16x32_bf16 v[4:7], v[100:103], v[112:115], 0
    v_mfma_f32_16x16x32_bf16 v[20:23], v[100:103], v[116:119], 0
    v_mfma_f32_16x16x32_bf16 v[36:39], v[100:103], v[120:123], 0
    v_mfma_f32_16x16x32_bf16 v[52:55], v[100:103], v[124:127], 0
    v_mfma_f32_16x16x32_bf16 v[68:71], v[100:103], v[128:131], 0
    v_mfma_f32_16x16x32_bf16 v[84:87], v[100:103], v[132:135], 0
    v_mfma_f32_16x16x32_bf16 v[8:11], v[104:107], v[112:115], 0
    v_mfma_f32_16x16x32_bf16 v[24:27], v[104:107], v[116:119], 0
    v_mfma_f32_16x16x32_bf16 v[40:43], v[104:107], v[120:123], 0
    v_mfma_f32_16x16x32_bf16 v[56:59], v[104:107], v[124:127], 0
    v_mfma_f32_16x16x32_bf16 v[72:75], v[104:107], v[128:131], 0
    v_mfma_f32_16x16x32_bf16 v[88:91], v[104:107], v[132:135], 0
    v_mfma_f32_16x16x32_bf16 v[12:15], v[108:111], v[112:115], 0
    s_cmp_ge_u32 s6, 9
    s_cselect_b32 s52, s51, s50
    s_add_u32 s52, s52, 3072
    buffer_load_dwordx4 v[112:115], v232, s[32:35], s52 offen offset:0 sc1
    v_mfma_f32_16x16x32_bf16 v[28:31], v[108:111], v[116:119], 0
    buffer_load_dwordx4 v[116:119], v233, s[32:35], s52 offen offset:0 sc1
    v_mfma_f32_16x16x32_bf16 v[44:47], v[108:111], v[120:123], 0
    buffer_load_dwordx4 v[120:123], v234, s[32:35], s52 offen offset:0 sc1
    v_mfma_f32_16x16x32_bf16 v[60:63], v[108:111], v[124:127], 0
    buffer_load_dwordx4 v[124:127], v235, s[32:35], s52 offen offset:0 sc1
    v_mfma_f32_16x16x32_bf16 v[76:79], v[108:111], v[128:131], 0
    buffer_load_dwordx4 v[128:131], v236, s[32:35], s52 offen offset:0 sc1
    v_mfma_f32_16x16x32_bf16 v[92:95], v[108:111], v[132:135], 0
    s_mov_b64 exec, s[4:5]
    buffer_load_dwordx4 v[132:135], v237, s[32:35], s52 offen offset:0 sc1
    s_mov_b64 exec, -1
    s_waitcnt vmcnt(12)
    v_mfma_f32_16x16x32_bf16 v[0:3], v[184:187], v[136:139], v[0:3]
    v_mfma_f32_16x16x32_bf16 v[16:19], v[184:187], v[140:143], v[16:19]
    v_mfma_f32_16x16x32_bf16 v[32:35], v[184:187], v[144:147], v[32:35]
    v_mfma_f32_16x16x32_bf16 v[48:51], v[184:187], v[148:151], v[48:51]
    v_mfma_f32_16x16x32_bf16 v[64:67], v[184:187], v[152:155], v[64:67]
    v_mfma_f32_16x16x32_bf16 v[80:83], v[184:187], v[156:159], v[80:83]
    v_mfma_f32_16x16x32_bf16 v[4:7], v[188:191], v[136:139], v[4:7]
    v_mfma_f32_16x16x32_bf16 v[20:23], v[188:191], v[140:143], v[20:23]
    v_mfma_f32_16x16x32_bf16 v[36:39], v[188:191], v[144:147], v[36:39]
    v_mfma_f32_16x16x32_bf16 v[52:55], v[188:191], v[148:151], v[52:55]
    v_mfma_f32_16x16x32_bf16 v[68:71], v[188:191], v[152:155], v[68:71]
    v_mfma_f32_16x16x32_bf16 v[84:87], v[188:191], v[156:159], v[84:87]
    v_mfma_f32_16x16x32_bf16 v[8:11], v[192:195], v[136:139], v[8:11]
    v_mfma_f32_16x16x32_bf16 v[24:27], v[192:195], v[140:143], v[24:27]
    v_mfma_f32_16x16x32_bf16 v[40:43], v[192:195], v[144:147], v[40:43]
    v_mfma_f32_16x16x32_bf16 v[56:59], v[192:195], v[148:151], v[56:59]
    v_mfma_f32_16x16x32_bf16 v[72:75], v[192:195], v[152:155], v[72:75]
    v_mfma_f32_16x16x32_bf16 v[88:91], v[192:195], v[156:159], v[88:91]
    v_mfma_f32_16x16x32_bf16 v[12:15], v[196:199], v[136:139], v[12:15]
    s_cmp_ge_u32 s6, 8
    s_cselect_b32 s52, s51, s50
    s_add_u32 s52, s52, 4096
    buffer_load_dwordx4 v[136:139], v232, s[32:35], s52 offen offset:0 sc1
    v_mfma_f32_16x16x32_bf16 v[28:31], v[196:199], v[140:143], v[28:31]
    buffer_load_dwordx4 v[140:143], v233, s[32:35], s52 offen offset:0 sc1
    v_mfma_f32_16x16x32_bf16 v[44:47], v[196:199], v[144:147], v[44:47]
    buffer_load_dwordx4 v[144:147], v234, s[32:35], s52 offen offset:0 sc1
    v_mfma_f32_16x16x32_bf16 v[60:63], v[196:199], v[148:151], v[60:63]
    buffer_load_dwordx4 v[148:151], v235, s[32:35], s52 offen offset:0 sc1
    v_mfma_f32_16x16x32_bf16 v[76:79], v[196:199], v[152:155], v[76:79]
    buffer_load_dwordx4 v[152:155], v236, s[32:35], s52 offen offset:0 sc1
    v_mfma_f32_16x16x32_bf16 v[92:95], v[196:199], v[156:159], v[92:95]
    s_mov_b64 exec, s[4:5]
    buffer_load_dwordx4 v[156:159], v237, s[32:35], s52 offen offset:0 sc1
    s_mov_b64 exec, -1
    s_waitcnt vmcnt(12)
    v_mfma_f32_16x16x32_bf16 v[0:3], v[200:203], v[160:163], v[0:3]
    v_mfma_f32_16x16x32_bf16 v[16:19], v[200:203], v[164:167], v[16:19]
    v_mfma_f32_16x16x32_bf16 v[32:35], v[200:203], v[168:171], v[32:35]
    v_mfma_f32_16x16x32_bf16 v[48:51], v[200:203], v[172:175], v[48:51]
    v_mfma_f32_16x16x32_bf16 v[64:67], v[200:203], v[176:179], v[64:67]
    v_mfma_f32_16x16x32_bf16 v[80:83], v[200:203], v[180:183], v[80:83]
    v_mfma_f32_16x16x32_bf16 v[4:7], v[204:207], v[160:163], v[4:7]
    v_mfma_f32_16x16x32_bf16 v[20:23], v[204:207], v[164:167], v[20:23]
    v_mfma_f32_16x16x32_bf16 v[36:39], v[204:207], v[168:171], v[36:39]
    v_mfma_f32_16x16x32_bf16 v[52:55], v[204:207], v[172:175], v[52:55]
    v_mfma_f32_16x16x32_bf16 v[68:71], v[204:207], v[176:179], v[68:71]
    v_mfma_f32_16x16x32_bf16 v[84:87], v[204:207], v[180:183], v[84:87]
    v_mfma_f32_16x16x32_bf16 v[8:11], v[208:211], v[160:163], v[8:11]
    v_mfma_f32_16x16x32_bf16 v[24:27], v[208:211], v[164:167], v[24:27]
    v_mfma_f32_16x16x32_bf16 v[40:43], v[208:211], v[168:171], v[40:43]
    v_mfma_f32_16x16x32_bf16 v[56:59], v[208:211], v[172:175], v[56:59]
    v_mfma_f32_16x16x32_bf16 v[72:75], v[208:211], v[176:179], v[72:75]
    v_mfma_f32_16x16x32_bf16 v[88:91], v[208:211], v[180:183], v[88:91]
    v_mfma_f32_16x16x32_bf16 v[12:15], v[212:215], v[160:163], v[12:15]
    s_cmp_ge_u32 s6, 7
    s_cselect_b32 s52, s51, s50
    s_add_u32 s52, s52, 5120
    buffer_load_dwordx4 v[160:163], v232, s[32:35], s52 offen offset:0 sc1
    v_mfma_f32_16x16x32_bf16 v[28:31], v[212:215], v[164:167], v[28:31]
    buffer_load_dwordx4 v[164:167], v233, s[32:35], s52 offen offset:0 sc1
    v_mfma_f32_16x16x32_bf16 v[44:47], v[212:215], v[168:171], v[44:47]
    buffer_load_dwordx4 v[168:171], v234, s[32:35], s52 offen offset:0 sc1
    v_mfma_f32_16x16x32_bf16 v[60:63], v[212:215], v[172:175], v[60:63]
    buffer_load_dwordx4 v[172:175], v235, s[32:35], s52 offen offset:0 sc1
    v_mfma_f32_16x16x32_bf16 v[76:79], v[212:215], v[176:179], v[76:79]
    buffer_load_dwordx4 v[176:179], v236, s[32:35], s52 offen offset:0 sc1
    v_mfma_f32_16x16x32_bf16 v[92:95], v[212:215], v[180:183], v[92:95]
    s_mov_b64 exec, s[4:5]
    buffer_load_dwordx4 v[180:183], v237, s[32:35], s52 offen offset:0 sc1
    s_mov_b64 exec, -1
    s_cmp_ge_u32 s6, 6
    s_cselect_b32 s52, s51, s50
    s_add_u32 s52, s52, 6144
    buffer_load_dwordx4 v[184:187], v232, s[32:35], s52 offen offset:0 sc1
    buffer_load_dwordx4 v[188:191], v233, s[32:35], s52 offen offset:0 sc1
    buffer_load_dwordx4 v[192:195], v234, s[32:35], s52 offen offset:0 sc1
    buffer_load_dwordx4 v[196:199], v235, s[32:35], s52 offen offset:0 sc1
    buffer_load_dwordx4 v[200:203], v236, s[32:35], s52 offen offset:0 sc1
    s_mov_b64 exec, s[4:5]
    buffer_load_dwordx4 v[204:207], v237, s[32:35], s52 offen offset:0 sc1
    s_mov_b64 exec, -1
    s_waitcnt vmcnt(18)
    v_mfma_f32_16x16x32_bf16 v[0:3], v[216:219], v[112:115], v[0:3]
    v_mfma_f32_16x16x32_bf16 v[16:19], v[216:219], v[116:119], v[16:19]
    v_mfma_f32_16x16x32_bf16 v[32:35], v[216:219], v[120:123], v[32:35]
    v_mfma_f32_16x16x32_bf16 v[48:51], v[216:219], v[124:127], v[48:51]
    v_mfma_f32_16x16x32_bf16 v[64:67], v[216:219], v[128:131], v[64:67]
    v_mfma_f32_16x16x32_bf16 v[80:83], v[216:219], v[132:135], v[80:83]
    v_add_u32 v240, 0x10000, v240
    ds_read_b64_tr_b16 v[96:97], v240 offset:0
    ds_read_b64_tr_b16 v[98:99], v240 offset:1024
    v_mfma_f32_16x16x32_bf16 v[4:7], v[220:223], v[112:115], v[4:7]
    v_mfma_f32_16x16x32_bf16 v[20:23], v[220:223], v[116:119], v[20:23]
    v_mfma_f32_16x16x32_bf16 v[36:39], v[220:223], v[120:123], v[36:39]
    v_mfma_f32_16x16x32_bf16 v[52:55], v[220:223], v[124:127], v[52:55]
    v_mfma_f32_16x16x32_bf16 v[68:71], v[220:223], v[128:131], v[68:71]
    v_mfma_f32_16x16x32_bf16 v[84:87], v[220:223], v[132:135], v[84:87]
    v_add_u32 v241, 0x10000, v241
    ds_read_b64_tr_b16 v[100:101], v241 offset:0
    ds_read_b64_tr_b16 v[102:103], v241 offset:1024
    v_mfma_f32_16x16x32_bf16 v[8:11], v[224:227], v[112:115], v[8:11]
    v_mfma_f32_16x16x32_bf16 v[24:27], v[224:227], v[116:119], v[24:27]
    v_mfma_f32_16x16x32_bf16 v[40:43], v[224:227], v[120:123], v[40:43]
    v_mfma_f32_16x16x32_bf16 v[56:59], v[224:227], v[124:127], v[56:59]
    v_mfma_f32_16x16x32_bf16 v[72:75], v[224:227], v[128:131], v[72:75]
    v_mfma_f32_16x16x32_bf16 v[88:91], v[224:227], v[132:135], v[88:91]
    v_add_u32 v242, 0x10000, v242
    ds_read_b64_tr_b16 v[104:105], v242 offset:0
    ds_read_b64_tr_b16 v[106:107], v242 offset:1024
    v_mfma_f32_16x16x32_bf16 v[12:15], v[228:231], v[112:115], v[12:15]
    s_cmp_ge_u32 s6, 5
    s_cselect_b32 s52, s51, s50
    s_add_u32 s52, s52, 7168
    buffer_load_dwordx4 v[112:115], v232, s[32:35], s52 offen offset:0 sc1
    v_mfma_f32_16x16x32_bf16 v[28:31], v[228:231], v[116:119], v[28:31]
    buffer_load_dwordx4 v[116:119], v233, s[32:35], s52 offen offset:0 sc1
    v_mfma_f32_16x16x32_bf16 v[44:47], v[228:231], v[120:123], v[44:47]
    buffer_load_dwordx4 v[120:123], v234, s[32:35], s52 offen offset:0 sc1
    v_mfma_f32_16x16x32_bf16 v[60:63], v[228:231], v[124:127], v[60:63]
    buffer_load_dwordx4 v[124:127], v235, s[32:35], s52 offen offset:0 sc1
    v_mfma_f32_16x16x32_bf16 v[76:79], v[228:231], v[128:131], v[76:79]
    buffer_load_dwordx4 v[128:131], v236, s[32:35], s52 offen offset:0 sc1
    v_mfma_f32_16x16x32_bf16 v[92:95], v[228:231], v[132:135], v[92:95]
    s_mov_b64 exec, s[4:5]
    buffer_load_dwordx4 v[132:135], v237, s[32:35], s52 offen offset:0 sc1
    s_mov_b64 exec, -1
    v_add_u32 v243, 0x10000, v243
    ds_read_b64_tr_b16 v[108:109], v243 offset:0
    ds_read_b64_tr_b16 v[110:111], v243 offset:1024
    s_cmp_ge_u32 s6, 4
    s_cselect_b32 s52, s51, s50
    s_add_u32 s52, s52, 8192
    buffer_load_dwordx4 v[208:211], v232, s[32:35], s52 offen offset:0 sc1
    buffer_load_dwordx4 v[212:215], v233, s[32:35], s52 offen offset:0 sc1
    buffer_load_dwordx4 v[216:219], v234, s[32:35], s52 offen offset:0 sc1
    buffer_load_dwordx4 v[220:223], v235, s[32:35], s52 offen offset:0 sc1
    buffer_load_dwordx4 v[224:227], v236, s[32:35], s52 offen offset:0 sc1
    s_mov_b64 exec, s[4:5]
    buffer_load_dwordx4 v[228:231], v237, s[32:35], s52 offen offset:0 sc1
    s_mov_b64 exec, -1
    s_waitcnt vmcnt(24)
    s_waitcnt lgkmcnt(6)
    v_mfma_f32_16x16x32_bf16 v[0:3], v[96:99], v[136:139], v[0:3]
    v_mfma_f32_16x16x32_bf16 v[16:19], v[96:99], v[140:143], v[16:19]
    v_mfma_f32_16x16x32_bf16 v[32:35], v[96:99], v[144:147], v[32:35]
    v_mfma_f32_16x16x32_bf16 v[48:51], v[96:99], v[148:151], v[48:51]
    v_mfma_f32_16x16x32_bf16 v[64:67], v[96:99], v[152:155], v[64:67]
    v_mfma_f32_16x16x32_bf16 v[80:83], v[96:99], v[156:159], v[80:83]
    ds_read_b64_tr_b16 v[96:97], v240 offset:16384
    ds_read_b64_tr_b16 v[98:99], v240 offset:17408
    s_waitcnt lgkmcnt(6)
    v_mfma_f32_16x16x32_bf16 v[4:7], v[100:103], v[136:139], v[4:7]
    v_mfma_f32_16x16x32_bf16 v[20:23], v[100:103], v[140:143], v[20:23]
    v_mfma_f32_16x16x32_bf16 v[36:39], v[100:103], v[144:147], v[36:39]
    v_mfma_f32_16x16x32_bf16 v[52:55], v[100:103], v[148:151], v[52:55]
    v_mfma_f32_16x16x32_bf16 v[68:71], v[100:103], v[152:155], v[68:71]
    v_mfma_f32_16x16x32_bf16 v[84:87], v[100:103], v[156:159], v[84:87]
    ds_read_b64_tr_b16 v[100:101], v241 offset:16384
    ds_read_b64_tr_b16 v[102:103], v241 offset:17408
    s_waitcnt lgkmcnt(6)
    v_mfma_f32_16x16x32_bf16 v[8:11], v[104:107], v[136:139], v[8:11]
    v_mfma_f32_16x16x32_bf16 v[24:27], v[104:107], v[140:143], v[24:27]
    v_mfma_f32_16x16x32_bf16 v[40:43], v[104:107], v[144:147], v[40:43]
    v_mfma_f32_16x16x32_bf16 v[56:59], v[104:107], v[148:151], v[56:59]
    v_mfma_f32_16x16x32_bf16 v[72:75], v[104:107], v[152:155], v[72:75]
    v_mfma_f32_16x16x32_bf16 v[88:91], v[104:107], v[156:159], v[88:91]
    ds_read_b64_tr_b16 v[104:105], v242 offset:16384
    ds_read_b64_tr_b16 v[106:107], v242 offset:17408
    s_waitcnt lgkmcnt(6)
    v_mfma_f32_16x16x32_bf16 v[12:15], v[108:111], v[136:139], v[12:15]
    s_cmp_ge_u32 s6, 3
    s_cselect_b32 s52, s51, s50
    s_add_u32 s52, s52, 9216
    buffer_load_dwordx4 v[136:139], v232, s[32:35], s52 offen offset:0 sc1
    v_mfma_f32_16x16x32_bf16 v[28:31], v[108:111], v[140:143], v[28:31]
    buffer_load_dwordx4 v[140:143], v233, s[32:35], s52 offen offset:0 sc1
    v_mfma_f32_16x16x32_bf16 v[44:47], v[108:111], v[144:147], v[44:47]
    buffer_load_dwordx4 v[144:147], v234, s[32:35], s52 offen offset:0 sc1
    v_mfma_f32_16x16x32_bf16 v[60:63], v[108:111], v[148:151], v[60:63]
    buffer_load_dwordx4 v[148:151], v235, s[32:35], s52 offen offset:0 sc1
    v_mfma_f32_16x16x32_bf16 v[76:79], v[108:111], v[152:155], v[76:79]
    buffer_load_dwordx4 v[152:155], v236, s[32:35], s52 offen offset:0 sc1
    v_mfma_f32_16x16x32_bf16 v[92:95], v[108:111], v[156:159], v[92:95]
    s_mov_b64 exec, s[4:5]
    buffer_load_dwordx4 v[156:159], v237, s[32:35], s52 offen offset:0 sc1
    s_mov_b64 exec, -1
    ds_read_b64_tr_b16 v[108:109], v243 offset:16384
    ds_read_b64_tr_b16 v[110:111], v243 offset:17408
    s_waitcnt vmcnt(24)
    s_waitcnt lgkmcnt(6)
    v_mfma_f32_16x16x32_bf16 v[0:3], v[96:99], v[160:163], v[0:3]
    v_mfma_f32_16x16x32_bf16 v[16:19], v[96:99], v[164:167], v[16:19]
    v_mfma_f32_16x16x32_bf16 v[32:35], v[96:99], v[168:171], v[32:35]
    v_mfma_f32_16x16x32_bf16 v[48:51], v[96:99], v[172:175], v[48:51]
    v_mfma_f32_16x16x32_bf16 v[64:67], v[96:99], v[176:179], v[64:67]
    v_mfma_f32_16x16x32_bf16 v[80:83], v[96:99], v[180:183], v[80:83]
    ds_read_b64_tr_b16 v[96:97], v240 offset:32768
    ds_read_b64_tr_b16 v[98:99], v240 offset:33792
    s_waitcnt lgkmcnt(6)
    v_mfma_f32_16x16x32_bf16 v[4:7], v[100:103], v[160:163], v[4:7]
    v_mfma_f32_16x16x32_bf16 v[20:23], v[100:103], v[164:167], v[20:23]
    v_mfma_f32_16x16x32_bf16 v[36:39], v[100:103], v[168:171], v[36:39]
    v_mfma_f32_16x16x32_bf16 v[52:55], v[100:103], v[172:175], v[52:55]
    v_mfma_f32_16x16x32_bf16 v[68:71], v[100:103], v[176:179], v[68:71]
    v_mfma_f32_16x16x32_bf16 v[84:87], v[100:103], v[180:183], v[84:87]
    ds_read_b64_tr_b16 v[100:101], v241 offset:32768
    ds_read_b64_tr_b16 v[102:103], v241 offset:33792
    s_waitcnt lgkmcnt(6)
    v_mfma_f32_16x16x32_bf16 v[8:11], v[104:107], v[160:163], v[8:11]
    v_mfma_f32_16x16x32_bf16 v[24:27], v[104:107], v[164:167], v[24:27]
    v_mfma_f32_16x16x32_bf16 v[40:43], v[104:107], v[168:171], v[40:43]
    v_mfma_f32_16x16x32_bf16 v[56:59], v[104:107], v[172:175], v[56:59]
    v_mfma_f32_16x16x32_bf16 v[72:75], v[104:107], v[176:179], v[72:75]
    v_mfma_f32_16x16x32_bf16 v[88:91], v[104:107], v[180:183], v[88:91]
    ds_read_b64_tr_b16 v[104:105], v242 offset:32768
    ds_read_b64_tr_b16 v[106:107], v242 offset:33792
    s_waitcnt lgkmcnt(6)
    v_mfma_f32_16x16x32_bf16 v[12:15], v[108:111], v[160:163], v[12:15]
    s_cmp_ge_u32 s6, 2
    s_cselect_b32 s52, s51, s50
    s_add_u32 s52, s52, 10240
    buffer_load_dwordx4 v[160:163], v232, s[32:35], s52 offen offset:0 sc1
    v_mfma_f32_16x16x32_bf16 v[28:31], v[108:111], v[164:167], v[28:31]
    buffer_load_dwordx4 v[164:167], v233, s[32:35], s52 offen offset:0 sc1
    v_mfma_f32_16x16x32_bf16 v[44:47], v[108:111], v[168:171], v[44:47]
    buffer_load_dwordx4 v[168:171], v234, s[32:35], s52 offen offset:0 sc1
    v_mfma_f32_16x16x32_bf16 v[60:63], v[108:111], v[172:175], v[60:63]
    buffer_load_dwordx4 v[172:175], v235, s[32:35], s52 offen offset:0 sc1
    v_mfma_f32_16x16x32_bf16 v[76:79], v[108:111], v[176:179], v[76:79]
    buffer_load_dwordx4 v[176:179], v236, s[32:35], s52 offen offset:0 sc1
    v_mfma_f32_16x16x32_bf16 v[92:95], v[108:111], v[180:183], v[92:95]
    s_mov_b64 exec, s[4:5]
    buffer_load_dwordx4 v[180:183], v237, s[32:35], s52 offen offset:0 sc1
    s_mov_b64 exec, -1
    ds_read_b64_tr_b16 v[108:109], v243 offset:32768
    ds_read_b64_tr_b16 v[110:111], v243 offset:33792
    s_waitcnt vmcnt(24)
    s_waitcnt lgkmcnt(6)
    v_mfma_f32_16x16x32_bf16 v[0:3], v[96:99], v[184:187], v[0:3]
    v_mfma_f32_16x16x32_bf16 v[16:19], v[96:99], v[188:191], v[16:19]
    v_mfma_f32_16x16x32_bf16 v[32:35], v[96:99], v[192:195], v[32:35]
    v_mfma_f32_16x16x32_bf16 v[48:51], v[96:99], v[196:199], v[48:51]
    v_mfma_f32_16x16x32_bf16 v[64:67], v[96:99], v[200:203], v[64:67]
    v_mfma_f32_16x16x32_bf16 v[80:83], v[96:99], v[204:207], v[80:83]
    ds_read_b64_tr_b16 v[96:97], v240 offset:49152
    ds_read_b64_tr_b16 v[98:99], v240 offset:50176
    s_waitcnt lgkmcnt(6)
    v_mfma_f32_16x16x32_bf16 v[4:7], v[100:103], v[184:187], v[4:7]
    v_mfma_f32_16x16x32_bf16 v[20:23], v[100:103], v[188:191], v[20:23]
    v_mfma_f32_16x16x32_bf16 v[36:39], v[100:103], v[192:195], v[36:39]
    v_mfma_f32_16x16x32_bf16 v[52:55], v[100:103], v[196:199], v[52:55]
    v_mfma_f32_16x16x32_bf16 v[68:71], v[100:103], v[200:203], v[68:71]
    v_mfma_f32_16x16x32_bf16 v[84:87], v[100:103], v[204:207], v[84:87]
    ds_read_b64_tr_b16 v[100:101], v241 offset:49152
    ds_read_b64_tr_b16 v[102:103], v241 offset:50176
    s_waitcnt lgkmcnt(6)
    v_mfma_f32_16x16x32_bf16 v[8:11], v[104:107], v[184:187], v[8:11]
    v_mfma_f32_16x16x32_bf16 v[24:27], v[104:107], v[188:191], v[24:27]
    v_mfma_f32_16x16x32_bf16 v[40:43], v[104:107], v[192:195], v[40:43]
    v_mfma_f32_16x16x32_bf16 v[56:59], v[104:107], v[196:199], v[56:59]
    v_mfma_f32_16x16x32_bf16 v[72:75], v[104:107], v[200:203], v[72:75]
    v_mfma_f32_16x16x32_bf16 v[88:91], v[104:107], v[204:207], v[88:91]
    ds_read_b64_tr_b16 v[104:105], v242 offset:49152
    ds_read_b64_tr_b16 v[106:107], v242 offset:50176
    s_waitcnt lgkmcnt(6)
    v_mfma_f32_16x16x32_bf16 v[12:15], v[108:111], v[184:187], v[12:15]
    s_cmp_ge_u32 s6, 1
    s_cselect_b32 s52, s51, s50
    s_add_u32 s52, s52, 11264
    buffer_load_dwordx4 v[184:187], v232, s[32:35], s52 offen offset:0 sc1
    v_mfma_f32_16x16x32_bf16 v[28:31], v[108:111], v[188:191], v[28:31]
    buffer_load_dwordx4 v[188:191], v233, s[32:35], s52 offen offset:0 sc1
    v_mfma_f32_16x16x32_bf16 v[44:47], v[108:111], v[192:195], v[44:47]
    buffer_load_dwordx4 v[192:195], v234, s[32:35], s52 offen offset:0 sc1
    v_mfma_f32_16x16x32_bf16 v[60:63], v[108:111], v[196:199], v[60:63]
    buffer_load_dwordx4 v[196:199], v235, s[32:35], s52 offen offset:0 sc1
    v_mfma_f32_16x16x32_bf16 v[76:79], v[108:111], v[200:203], v[76:79]
    buffer_load_dwordx4 v[200:203], v236, s[32:35], s52 offen offset:0 sc1
    v_mfma_f32_16x16x32_bf16 v[92:95], v[108:111], v[204:207], v[92:95]
    s_mov_b64 exec, s[4:5]
    buffer_load_dwordx4 v[204:207], v237, s[32:35], s52 offen offset:0 sc1
    s_mov_b64 exec, -1
    ds_read_b64_tr_b16 v[108:109], v243 offset:49152
    ds_read_b64_tr_b16 v[110:111], v243 offset:50176
    s_waitcnt vmcnt(24)
    s_waitcnt lgkmcnt(6)
    v_mfma_f32_16x16x32_bf16 v[0:3], v[96:99], v[112:115], v[0:3]
    s_add_u32 s46, s65, 0
    s_lshr_b32 s46, s46, 1
    s_lshl_b32 s46, s46, 4
    v_add_u32 v232, s46, v254
    v_mul_u32_u24 v252, 1150, v232
    v_lshrrev_b32 v252, 16, v252
    v_lshl_add_u32 v232, v252, 5, v232
    v_lshl_add_u32 v232, v232, 4, v253
    v_mfma_f32_16x16x32_bf16 v[16:19], v[96:99], v[116:119], v[16:19]
    v_mfma_f32_16x16x32_bf16 v[32:35], v[96:99], v[120:123], v[32:35]
    s_add_u32 s46, s65, 1
    s_lshr_b32 s46, s46, 1
    s_lshl_b32 s46, s46, 4
    v_add_u32 v233, s46, v254
    v_mul_u32_u24 v252, 1150, v233
    v_lshrrev_b32 v252, 16, v252
    v_lshl_add_u32 v233, v252, 5, v233
    v_lshl_add_u32 v233, v233, 4, v253
    v_mfma_f32_16x16x32_bf16 v[48:51], v[96:99], v[124:127], v[48:51]
    v_mfma_f32_16x16x32_bf16 v[64:67], v[96:99], v[128:131], v[64:67]
    s_add_u32 s46, s65, 2
    s_lshr_b32 s46, s46, 1
    s_lshl_b32 s46, s46, 4
    v_add_u32 v234, s46, v254
    v_mul_u32_u24 v252, 1150, v234
    v_lshrrev_b32 v252, 16, v252
    v_lshl_add_u32 v234, v252, 5, v234
    v_lshl_add_u32 v234, v234, 4, v253
    v_mfma_f32_16x16x32_bf16 v[80:83], v[96:99], v[132:135], v[80:83]
    v_add_u32 v240, 0x10000, v240
    ds_read_b64_tr_b16 v[96:97], v240 offset:0
    ds_read_b64_tr_b16 v[98:99], v240 offset:1024
    s_waitcnt lgkmcnt(6)
    v_mfma_f32_16x16x32_bf16 v[4:7], v[100:103], v[112:115], v[4:7]
    s_add_u32 s46, s65, 3
    s_lshr_b32 s46, s46, 1
    s_lshl_b32 s46, s46, 4
    v_add_u32 v235, s46, v254
    v_mul_u32_u24 v252, 1150, v235
    v_lshrrev_b32 v252, 16, v252
    v_lshl_add_u32 v235, v252, 5, v235
    v_lshl_add_u32 v235, v235, 4, v253
    v_mfma_f32_16x16x32_bf16 v[20:23], v[100:103], v[116:119], v[20:23]
    v_mfma_f32_16x16x32_bf16 v[36:39], v[100:103], v[120:123], v[36:39]
    s_add_u32 s46, s65, 4
    s_lshr_b32 s46, s46, 1
    s_lshl_b32 s46, s46, 4
    v_add_u32 v236, s46, v254
    v_mul_u32_u24 v252, 1150, v236
    v_lshrrev_b32 v252, 16, v252
    v_lshl_add_u32 v236, v252, 5, v236
    v_lshl_add_u32 v236, v236, 4, v253
    v_mfma_f32_16x16x32_bf16 v[52:55], v[100:103], v[124:127], v[52:55]
    v_mfma_f32_16x16x32_bf16 v[68:71], v[100:103], v[128:131], v[68:71]
    s_add_u32 s46, s65, 5
    s_lshr_b32 s46, s46, 1
    s_lshl_b32 s46, s46, 4
    v_add_u32 v237, s46, v254
    v_mul_u32_u24 v252, 1150, v237
    v_lshrrev_b32 v252, 16, v252
    v_lshl_add_u32 v237, v252, 5, v237
    v_lshl_add_u32 v237, v237, 4, v253
    s_cmp_eq_u32 s66, 5
    s_cselect_b32 s46, 0x40000000, 0
    v_or_b32 v237, s46, v237
    v_mfma_f32_16x16x32_bf16 v[84:87], v[100:103], v[132:135], v[84:87]
    v_add_u32 v241, 0x10000, v241
    ds_read_b64_tr_b16 v[100:101], v241 offset:0
    ds_read_b64_tr_b16 v[102:103], v241 offset:1024
    ds_read_b32 v246, v245 offset:8
    s_waitcnt lgkmcnt(7)
    v_mfma_f32_16x16x32_bf16 v[8:11], v[104:107], v[112:115], v[8:11]
    v_mfma_f32_16x16x32_bf16 v[24:27], v[104:107], v[116:119], v[24:27]
    v_mfma_f32_16x16x32_bf16 v[40:43], v[104:107], v[120:123], v[40:43]
    v_mfma_f32_16x16x32_bf16 v[56:59], v[104:107], v[124:127], v[56:59]
    v_mfma_f32_16x16x32_bf16 v[72:75], v[104:107], v[128:131], v[72:75]
    v_mfma_f32_16x16x32_bf16 v[88:91], v[104:107], v[132:135], v[88:91]
    v_add_u32 v242, 0x10000, v242
    ds_read_b64_tr_b16 v[104:105], v242 offset:0
    ds_read_b64_tr_b16 v[106:107], v242 offset:1024
    s_waitcnt lgkmcnt(7)
    s_waitcnt lgkmcnt(2)
    v_cmp_ne_u32 vcc, 0, v246
    s_cbranch_vccnz PO_OK
PO_SPIN:
    ds_read_b32 v246, v245 offset:8
    s_waitcnt lgkmcnt(0)
    v_cmp_ne_u32 vcc, 0, v246
    s_cbranch_vccz PO_SPIN
PO_OK:
    s_lshl_b32 s46, s65, 7
    s_add_u32 s46, s46, 12582976
    v_lshl_add_u32 v253, v254, 2, s46
    v_and_b32 v255, 0x40000000, v237
    v_or_b32 v255, v255, v253
    buffer_load_dword v244, v253, s[32:35], 0 offen offset:0 sc1
    buffer_load_dword v245, v253, s[32:35], 0 offen offset:128 sc1
    buffer_load_dword v246, v253, s[32:35], 0 offen offset:256 sc1
    buffer_load_dword v247, v253, s[32:35], 0 offen offset:384 sc1
    buffer_load_dword v252, v253, s[32:35], 0 offen offset:512 sc1
    buffer_load_dword v255, v255, s[32:35], 0 offen offset:640 sc1
    v_mfma_f32_16x16x32_bf16 v[12:15], v[108:111], v[112:115], v[12:15]
    buffer_load_dwordx4 v[112:115], v232, s[32:35], s10 offen offset:0 sc1
    v_mfma_f32_16x16x32_bf16 v[28:31], v[108:111], v[116:119], v[28:31]
    buffer_load_dwordx4 v[116:119], v233, s[32:35], s11 offen offset:0 sc1
    v_mfma_f32_16x16x32_bf16 v[44:47], v[108:111], v[120:123], v[44:47]
    buffer_load_dwordx4 v[120:123], v234, s[32:35], s10 offen offset:0 sc1
    v_mfma_f32_16x16x32_bf16 v[60:63], v[108:111], v[124:127], v[60:63]
    buffer_load_dwordx4 v[124:127], v235, s[32:35], s11 offen offset:0 sc1
    v_mfma_f32_16x16x32_bf16 v[76:79], v[108:111], v[128:131], v[76:79]
    buffer_load_dwordx4 v[128:131], v236, s[32:35], s10 offen offset:0 sc1
    v_mfma_f32_16x16x32_bf16 v[92:95], v[108:111], v[132:135], v[92:95]
    s_mov_b64 exec, s[4:5]
    buffer_load_dwordx4 v[132:135], v237, s[32:35], s11 offen offset:0 sc1
    s_mov_b64 exec, -1
    v_add_u32 v243, 0x10000, v243
    ds_read_b64_tr_b16 v[108:109], v243 offset:0
    ds_read_b64_tr_b16 v[110:111], v243 offset:1024
    s_add_u32 m0, s58, 65536
    s_add_u32 s46, s56, 51200
    buffer_load_dwordx4 v238, s[92:95], s46 offen offset:0 lds
    s_add_u32 s46, s56, 75776
    buffer_load_dwordx4 v238, s[92:95], s46 offen offset:1024 lds
    s_add_u32 s46, s56, 59392
    buffer_load_dwordx4 v238, s[92:95], s46 offen offset:2048 lds
    s_add_u32 s46, s56, 83968
    buffer_load_dwordx4 v238, s[92:95], s46 offen offset:3072 lds
    s_waitcnt vmcnt(34)
    v_mfma_f32_16x16x32_bf16 v[0:3], v[96:99], v[208:211], v[0:3]
    v_mfma_f32_16x16x32_bf16 v[16:19], v[96:99], v[212:215], v[16:19]
    v_mfma_f32_16x16x32_bf16 v[32:35], v[96:99], v[216:219], v[32:35]
    v_mfma_f32_16x16x32_bf16 v[48:51], v[96:99], v[220:223], v[48:51]
    v_mfma_f32_16x16x32_bf16 v[64:67], v[96:99], v[224:227], v[64:67]
    v_mfma_f32_16x16x32_bf16 v[80:83], v[96:99], v[228:231], v[80:83]
    v_add_u32 v240, 0xfffe0000, v240
    ds_read_b64_tr_b16 v[96:97], v240 offset:0
    ds_read_b64_tr_b16 v[98:99], v240 offset:1024
    v_mfma_f32_16x16x32_bf16 v[4:7], v[100:103], v[208:211], v[4:7]
    v_mfma_f32_16x16x32_bf16 v[20:23], v[100:103], v[212:215], v[20:23]
    v_mfma_f32_16x16x32_bf16 v[36:39], v[100:103], v[216:219], v[36:39]
    v_mfma_f32_16x16x32_bf16 v[52:55], v[100:103], v[220:223], v[52:55]
    v_mfma_f32_16x16x32_bf16 v[68:71], v[100:103], v[224:227], v[68:71]
    v_mfma_f32_16x16x32_bf16 v[84:87], v[100:103], v[228:231], v[84:87]
    v_add_u32 v241, 0xfffe0000, v241
    ds_read_b64_tr_b16 v[100:101], v241 offset:0
    ds_read_b64_tr_b16 v[102:103], v241 offset:1024
    s_waitcnt lgkmcnt(6)
    v_mfma_f32_16x16x32_bf16 v[8:11], v[104:107], v[208:211], v[8:11]
    v_mfma_f32_16x16x32_bf16 v[24:27], v[104:107], v[212:215], v[24:27]
    v_mfma_f32_16x16x32_bf16 v[40:43], v[104:107], v[216:219], v[40:43]
    v_mfma_f32_16x16x32_bf16 v[56:59], v[104:107], v[220:223], v[56:59]
    v_mfma_f32_16x16x32_bf16 v[72:75], v[104:107], v[224:227], v[72:75]
    v_mfma_f32_16x16x32_bf16 v[88:91], v[104:107], v[228:231], v[88:91]
    v_add_u32 v242, 0xfffe0000, v242
    ds_read_b64_tr_b16 v[104:105], v242 offset:0
    ds_read_b64_tr_b16 v[106:107], v242 offset:1024
    s_waitcnt lgkmcnt(6)
    v_mfma_f32_16x16x32_bf16 v[12:15], v[108:111], v[208:211], v[12:15]
    s_add_u32 s10, s10, 102400
    buffer_load_dwordx4 v[208:211], v232, s[32:35], s10 offen offset:0 sc1
    v_mfma_f32_16x16x32_bf16 v[28:31], v[108:111], v[212:215], v[28:31]
    s_add_u32 s11, s11, 102400
    buffer_load_dwordx4 v[212:215], v233, s[32:35], s11 offen offset:0 sc1
    v_mfma_f32_16x16x32_bf16 v[44:47], v[108:111], v[216:219], v[44:47]
    buffer_load_dwordx4 v[216:219], v234, s[32:35], s10 offen offset:0 sc1
    v_mfma_f32_16x16x32_bf16 v[60:63], v[108:111], v[220:223], v[60:63]
    buffer_load_dwordx4 v[220:223], v235, s[32:35], s11 offen offset:0 sc1
    v_mfma_f32_16x16x32_bf16 v[76:79], v[108:111], v[224:227], v[76:79]
    buffer_load_dwordx4 v[224:227], v236, s[32:35], s10 offen offset:0 sc1
    v_mfma_f32_16x16x32_bf16 v[92:95], v[108:111], v[228:231], v[92:95]
    s_mov_b64 exec, s[4:5]
    buffer_load_dwordx4 v[228:231], v237, s[32:35], s11 offen offset:0 sc1
    s_mov_b64 exec, -1
    v_add_u32 v243, 0xfffe0000, v243
    ds_read_b64_tr_b16 v[108:109], v243 offset:0
    ds_read_b64_tr_b16 v[110:111], v243 offset:1024
    s_add_u32 m0, s58, 81920
    s_add_u32 s46, s56, 102400
    buffer_load_dwordx4 v238, s[92:95], s46 offen offset:0 lds
    s_add_u32 s46, s56, 126976
    buffer_load_dwordx4 v238, s[92:95], s46 offen offset:1024 lds
    s_add_u32 s46, s56, 110592
    buffer_load_dwordx4 v238, s[92:95], s46 offen offset:2048 lds
    s_add_u32 s46, s56, 135168
    buffer_load_dwordx4 v238, s[92:95], s46 offen offset:3072 lds
    s_waitcnt vmcnt(38)
    s_waitcnt lgkmcnt(6)
    v_mfma_f32_16x16x32_bf16 v[0:3], v[96:99], v[136:139], v[0:3]
    v_mfma_f32_16x16x32_bf16 v[16:19], v[96:99], v[140:143], v[16:19]
    v_mfma_f32_16x16x32_bf16 v[32:35], v[96:99], v[144:147], v[32:35]
    v_mfma_f32_16x16x32_bf16 v[48:51], v[96:99], v[148:151], v[48:51]
    v_mfma_f32_16x16x32_bf16 v[64:67], v[96:99], v[152:155], v[64:67]
    v_mfma_f32_16x16x32_bf16 v[80:83], v[96:99], v[156:159], v[80:83]
    ds_read_b64_tr_b16 v[96:97], v240 offset:16384
    ds_read_b64_tr_b16 v[98:99], v240 offset:17408
    s_waitcnt lgkmcnt(6)
    v_mfma_f32_16x16x32_bf16 v[4:7], v[100:103], v[136:139], v[4:7]
    v_mfma_f32_16x16x32_bf16 v[20:23], v[100:103], v[140:143], v[20:23]
    v_mfma_f32_16x16x32_bf16 v[36:39], v[100:103], v[144:147], v[36:39]
    v_mfma_f32_16x16x32_bf16 v[52:55], v[100:103], v[148:151], v[52:55]
    v_mfma_f32_16x16x32_bf16 v[68:71], v[100:103], v[152:155], v[68:71]
    v_mfma_f32_16x16x32_bf16 v[84:87], v[100:103], v[156:159], v[84:87]
    ds_read_b64_tr_b16 v[100:101], v241 offset:16384
    ds_read_b64_tr_b16 v[102:103], v241 offset:17408
    s_waitcnt lgkmcnt(6)
    v_mfma_f32_16x16x32_bf16 v[8:11], v[104:107], v[136:139], v[8:11]
    v_mfma_f32_16x16x32_bf16 v[24:27], v[104:107], v[140:143], v[24:27]
    v_mfma_f32_16x16x32_bf16 v[40:43], v[104:107], v[144:147], v[40:43]
    v_mfma_f32_16x16x32_bf16 v[56:59], v[104:107], v[148:151], v[56:59]
    v_mfma_f32_16x16x32_bf16 v[72:75], v[104:107], v[152:155], v[72:75]
    v_mfma_f32_16x16x32_bf16 v[88:91], v[104:107], v[156:159], v[88:91]
    ds_read_b64_tr_b16 v[104:105], v242 offset:16384
    ds_read_b64_tr_b16 v[106:107], v242 offset:17408
    s_waitcnt lgkmcnt(6)
    v_mfma_f32_16x16x32_bf16 v[12:15], v[108:111], v[136:139], v[12:15]
    s_add_u32 s10, s10, 102400
    buffer_load_dwordx4 v[136:139], v232, s[32:35], s10 offen offset:0 sc1
    v_mfma_f32_16x16x32_bf16 v[28:31], v[108:111], v[140:143], v[28:31]
    s_add_u32 s11, s11, 102400
    buffer_load_dwordx4 v[140:143], v233, s[32:35], s11 offen offset:0 sc1
    v_mfma_f32_16x16x32_bf16 v[44:47], v[108:111], v[144:147], v[44:47]
    buffer_load_dwordx4 v[144:147], v234, s[32:35], s10 offen offset:0 sc1
    v_mfma_f32_16x16x32_bf16 v[60:63], v[108:111], v[148:151], v[60:63]
    buffer_load_dwordx4 v[148:151], v235, s[32:35], s11 offen offset:0 sc1
    v_mfma_f32_16x16x32_bf16 v[76:79], v[108:111], v[152:155], v[76:79]
    buffer_load_dwordx4 v[152:155], v236, s[32:35], s10 offen offset:0 sc1
    v_mfma_f32_16x16x32_bf16 v[92:95], v[108:111], v[156:159], v[92:95]
    s_mov_b64 exec, s[4:5]
    buffer_load_dwordx4 v[156:159], v237, s[32:35], s11 offen offset:0 sc1
    s_mov_b64 exec, -1
    ds_read_b64_tr_b16 v[108:109], v243 offset:16384
    ds_read_b64_tr_b16 v[110:111], v243 offset:17408
    s_add_u32 m0, s58, 98304
    s_add_u32 s46, s56, 153600
    buffer_load_dwordx4 v238, s[92:95], s46 offen offset:0 lds
    s_add_u32 s46, s56, 178176
    buffer_load_dwordx4 v238, s[92:95], s46 offen offset:1024 lds
    s_add_u32 s46, s56, 161792
    buffer_load_dwordx4 v238, s[92:95], s46 offen offset:2048 lds
    s_add_u32 s46, s56, 186368
    buffer_load_dwordx4 v238, s[92:95], s46 offen offset:3072 lds
    s_waitcnt vmcnt(42)
    s_waitcnt lgkmcnt(6)
    v_mfma_f32_16x16x32_bf16 v[0:3], v[96:99], v[160:163], v[0:3]
    v_mfma_f32_16x16x32_bf16 v[16:19], v[96:99], v[164:167], v[16:19]
    v_mfma_f32_16x16x32_bf16 v[32:35], v[96:99], v[168:171], v[32:35]
    v_mfma_f32_16x16x32_bf16 v[48:51], v[96:99], v[172:175], v[48:51]
    v_mfma_f32_16x16x32_bf16 v[64:67], v[96:99], v[176:179], v[64:67]
    v_mfma_f32_16x16x32_bf16 v[80:83], v[96:99], v[180:183], v[80:83]
    ds_read_b64_tr_b16 v[96:97], v240 offset:32768
    ds_read_b64_tr_b16 v[98:99], v240 offset:33792
    s_waitcnt lgkmcnt(6)
    v_mfma_f32_16x16x32_bf16 v[4:7], v[100:103], v[160:163], v[4:7]
    v_mfma_f32_16x16x32_bf16 v[20:23], v[100:103], v[164:167], v[20:23]
    v_mfma_f32_16x16x32_bf16 v[36:39], v[100:103], v[168:171], v[36:39]
    v_mfma_f32_16x16x32_bf16 v[52:55], v[100:103], v[172:175], v[52:55]
    v_mfma_f32_16x16x32_bf16 v[68:71], v[100:103], v[176:179], v[68:71]
    v_mfma_f32_16x16x32_bf16 v[84:87], v[100:103], v[180:183], v[84:87]
    ds_read_b64_tr_b16 v[100:101], v241 offset:32768
    ds_read_b64_tr_b16 v[102:103], v241 offset:33792
    s_waitcnt lgkmcnt(6)
    v_mfma_f32_16x16x32_bf16 v[8:11], v[104:107], v[160:163], v[8:11]
    v_mfma_f32_16x16x32_bf16 v[24:27], v[104:107], v[164:167], v[24:27]
    v_mfma_f32_16x16x32_bf16 v[40:43], v[104:107], v[168:171], v[40:43]
    v_mfma_f32_16x16x32_bf16 v[56:59], v[104:107], v[172:175], v[56:59]
    v_mfma_f32_16x16x32_bf16 v[72:75], v[104:107], v[176:179], v[72:75]
    v_mfma_f32_16x16x32_bf16 v[88:91], v[104:107], v[180:183], v[88:91]
    ds_read_b64_tr_b16 v[104:105], v242 offset:32768
    ds_read_b64_tr_b16 v[106:107], v242 offset:33792
    s_waitcnt lgkmcnt(6)
    v_mfma_f32_16x16x32_bf16 v[12:15], v[108:111], v[160:163], v[12:15]
    s_add_u32 s10, s10, 102400
    buffer_load_dwordx4 v[160:163], v232, s[32:35], s10 offen offset:0 sc1
    v_mfma_f32_16x16x32_bf16 v[28:31], v[108:111], v[164:167], v[28:31]
    s_add_u32 s11, s11, 102400
    buffer_load_dwordx4 v[164:167], v233, s[32:35], s11 offen offset:0 sc1
    v_mfma_f32_16x16x32_bf16 v[44:47], v[108:111], v[168:171], v[44:47]
    buffer_load_dwordx4 v[168:171], v234, s[32:35], s10 offen offset:0 sc1
    v_mfma_f32_16x16x32_bf16 v[60:63], v[108:111], v[172:175], v[60:63]
    buffer_load_dwordx4 v[172:175], v235, s[32:35], s11 offen offset:0 sc1
    v_mfma_f32_16x16x32_bf16 v[76:79], v[108:111], v[176:179], v[76:79]
    buffer_load_dwordx4 v[176:179], v236, s[32:35], s10 offen offset:0 sc1
    v_mfma_f32_16x16x32_bf16 v[92:95], v[108:111], v[180:183], v[92:95]
    s_mov_b64 exec, s[4:5]
    buffer_load_dwordx4 v[180:183], v237, s[32:35], s11 offen offset:0 sc1
    s_mov_b64 exec, -1
    ds_read_b64_tr_b16 v[108:109], v243 offset:32768
    ds_read_b64_tr_b16 v[110:111], v243 offset:33792
    s_add_u32 m0, s58, 114688
    s_add_u32 s46, s56, 20480
    buffer_load_dwordx4 v239, s[92:95], s46 offen offset:0 lds
    s_add_u32 s46, s56, 121856
    buffer_load_dwordx4 v239, s[92:95], s46 offen offset:1024 lds
    s_add_u32 s46, s56, 69632
    buffer_load_dwordx4 v239, s[92:95], s46 offen offset:2048 lds
    s_add_u32 s46, s56, 171008
    buffer_load_dwordx4 v239, s[92:95], s46 offen offset:3072 lds
    s_waitcnt vmcnt(46)
    s_waitcnt lgkmcnt(6)
    v_mfma_f32_16x16x32_bf16 v[0:3], v[96:99], v[184:187], v[0:3]
    v_mfma_f32_16x16x32_bf16 v[16:19], v[96:99], v[188:191], v[16:19]
    v_mfma_f32_16x16x32_bf16 v[32:35], v[96:99], v[192:195], v[32:35]
    v_mfma_f32_16x16x32_bf16 v[48:51], v[96:99], v[196:199], v[48:51]
    v_mfma_f32_16x16x32_bf16 v[64:67], v[96:99], v[200:203], v[64:67]
    v_mfma_f32_16x16x32_bf16 v[80:83], v[96:99], v[204:207], v[80:83]
    ds_read_b64_tr_b16 v[96:97], v240 offset:49152
    ds_read_b64_tr_b16 v[98:99], v240 offset:50176
    s_waitcnt lgkmcnt(6)
    v_mfma_f32_16x16x32_bf16 v[4:7], v[100:103], v[184:187], v[4:7]
    v_mfma_f32_16x16x32_bf16 v[20:23], v[100:103], v[188:191], v[20:23]
    v_mfma_f32_16x16x32_bf16 v[36:39], v[100:103], v[192:195], v[36:39]
    v_mfma_f32_16x16x32_bf16 v[52:55], v[100:103], v[196:199], v[52:55]
    v_mfma_f32_16x16x32_bf16 v[68:71], v[100:103], v[200:203], v[68:71]
    v_mfma_f32_16x16x32_bf16 v[84:87], v[100:103], v[204:207], v[84:87]
    ds_read_b64_tr_b16 v[100:101], v241 offset:49152
    ds_read_b64_tr_b16 v[102:103], v241 offset:50176
    s_waitcnt lgkmcnt(6)
    v_mfma_f32_16x16x32_bf16 v[8:11], v[104:107], v[184:187], v[8:11]
    v_mfma_f32_16x16x32_bf16 v[24:27], v[104:107], v[188:191], v[24:27]
    v_mfma_f32_16x16x32_bf16 v[40:43], v[104:107], v[192:195], v[40:43]
    v_mfma_f32_16x16x32_bf16 v[56:59], v[104:107], v[196:199], v[56:59]
    v_mfma_f32_16x16x32_bf16 v[72:75], v[104:107], v[200:203], v[72:75]
    v_mfma_f32_16x16x32_bf16 v[88:91], v[104:107], v[204:207], v[88:91]
    ds_read_b64_tr_b16 v[104:105], v242 offset:49152
    ds_read_b64_tr_b16 v[106:107], v242 offset:50176
    s_waitcnt lgkmcnt(6)
    s_waitcnt vmcnt(40)
    v_mfma_f32_16x16x32_bf16 v[12:15], v[108:111], v[184:187], v[12:15]
    v_lshrrev_b32 v232, 1, v232
    s_add_u32 s46, s53, 51200
    buffer_load_dwordx2 v[184:185], v232, s[32:35], s53 offen sc1
    buffer_load_dwordx2 v[186:187], v232, s[32:35], s46 offen sc1
    v_mul_f32 v0, v244, v0
    v_mul_f32 v1, v244, v1
    v_mul_f32 v2, v244, v2
    v_mul_f32 v3, v244, v3
    v_mfma_f32_16x16x32_bf16 v[28:31], v[108:111], v[188:191], v[28:31]
    v_lshrrev_b32 v233, 1, v233
    s_add_u32 s46, s57, 51200
    buffer_load_dwordx2 v[188:189], v233, s[32:35], s57 offen sc1
    buffer_load_dwordx2 v[190:191], v233, s[32:35], s46 offen sc1
    v_mul_f32 v16, v245, v16
    v_mul_f32 v17, v245, v17
    v_mul_f32 v18, v245, v18
    v_mul_f32 v19, v245, v19
    v_mfma_f32_16x16x32_bf16 v[44:47], v[108:111], v[192:195], v[44:47]
    v_lshrrev_b32 v234, 1, v234
    s_add_u32 s46, s53, 51200
    buffer_load_dwordx2 v[192:193], v234, s[32:35], s53 offen sc1
    buffer_load_dwordx2 v[194:195], v234, s[32:35], s46 offen sc1
    v_mul_f32 v32, v246, v32
    v_mul_f32 v33, v246, v33
    v_mul_f32 v34, v246, v34
    v_mul_f32 v35, v246, v35
    v_mfma_f32_16x16x32_bf16 v[60:63], v[108:111], v[196:199], v[60:63]
    v_lshrrev_b32 v235, 1, v235
    s_add_u32 s46, s57, 51200
    buffer_load_dwordx2 v[196:197], v235, s[32:35], s57 offen sc1
    buffer_load_dwordx2 v[198:199], v235, s[32:35], s46 offen sc1
    v_mul_f32 v48, v247, v48
    v_mul_f32 v49, v247, v49
    v_mul_f32 v50, v247, v50
    v_mul_f32 v51, v247, v51
    v_mfma_f32_16x16x32_bf16 v[76:79], v[108:111], v[200:203], v[76:79]
    v_lshrrev_b32 v236, 1, v236
    s_add_u32 s46, s53, 51200
    buffer_load_dwordx2 v[200:201], v236, s[32:35], s53 offen sc1
    buffer_load_dwordx2 v[202:203], v236, s[32:35], s46 offen sc1
    v_mul_f32 v64, v252, v64
    v_mul_f32 v65, v252, v65
    v_mul_f32 v66, v252, v66
    v_mul_f32 v67, v252, v67
    v_mfma_f32_16x16x32_bf16 v[92:95], v[108:111], v[204:207], v[92:95]
    v_lshrrev_b32 v237, 1, v237
    s_add_u32 s46, s57, 51200
    s_mov_b64 exec, s[4:5]
    buffer_load_dwordx2 v[204:205], v237, s[32:35], s57 offen sc1
    buffer_load_dwordx2 v[206:207], v237, s[32:35], s46 offen sc1
    s_mov_b64 exec, -1
    v_mul_f32 v80, v255, v80
    v_mul_f32 v81, v255, v81
    v_mul_f32 v82, v255, v82
    v_mul_f32 v83, v255, v83
    ds_read_b64_tr_b16 v[108:109], v243 offset:49152
    ds_read_b64_tr_b16 v[110:111], v243 offset:50176
    s_waitcnt vmcnt(42)
    s_waitcnt lgkmcnt(6)
    v_mfma_f32_16x16x32_bf16 v[0:3], v[96:99], v[112:115], v[0:3]
    v_mul_f32 v4, v244, v4
    v_mul_f32 v5, v244, v5
    v_mul_f32 v6, v244, v6
    v_mul_f32 v7, v244, v7
    v_mfma_f32_16x16x32_bf16 v[16:19], v[96:99], v[116:119], v[16:19]
    v_mul_f32 v20, v245, v20
    v_mul_f32 v21, v245, v21
    v_mul_f32 v22, v245, v22
    v_mul_f32 v23, v245, v23
    v_mfma_f32_16x16x32_bf16 v[32:35], v[96:99], v[120:123], v[32:35]
    v_mul_f32 v36, v246, v36
    v_mul_f32 v37, v246, v37
    v_mul_f32 v38, v246, v38
    v_mul_f32 v39, v246, v39
    v_mfma_f32_16x16x32_bf16 v[48:51], v[96:99], v[124:127], v[48:51]
    v_mul_f32 v52, v247, v52
    v_mul_f32 v53, v247, v53
    v_mul_f32 v54, v247, v54
    v_mul_f32 v55, v247, v55
    v_mfma_f32_16x16x32_bf16 v[64:67], v[96:99], v[128:131], v[64:67]
    v_mul_f32 v68, v252, v68
    v_mul_f32 v69, v252, v69
    v_mul_f32 v70, v252, v70
    v_mul_f32 v71, v252, v71
    v_mfma_f32_16x16x32_bf16 v[80:83], v[96:99], v[132:135], v[80:83]
    v_mul_f32 v84, v255, v84
    v_mul_f32 v85, v255, v85
    v_mul_f32 v86, v255, v86
    v_mul_f32 v87, v255, v87
    v_add_u32 v240, 0x10000, v240
    ds_read_b64_tr_b16 v[96:97], v240 offset:0
    ds_read_b64_tr_b16 v[98:99], v240 offset:1024
    s_waitcnt lgkmcnt(6)
    v_mfma_f32_16x16x32_bf16 v[4:7], v[100:103], v[112:115], v[4:7]
    v_mul_f32 v8, v244, v8
    v_mul_f32 v9, v244, v9
    v_mul_f32 v10, v244, v10
    v_mul_f32 v11, v244, v11
    v_mfma_f32_16x16x32_bf16 v[20:23], v[100:103], v[116:119], v[20:23]
    v_mul_f32 v24, v245, v24
    v_mul_f32 v25, v245, v25
    v_mul_f32 v26, v245, v26
    v_mul_f32 v27, v245, v27
    v_mfma_f32_16x16x32_bf16 v[36:39], v[100:103], v[120:123], v[36:39]
    v_mul_f32 v40, v246, v40
    v_mul_f32 v41, v246, v41
    v_mul_f32 v42, v246, v42
    v_mul_f32 v43, v246, v43
    v_mfma_f32_16x16x32_bf16 v[52:55], v[100:103], v[124:127], v[52:55]
    v_mul_f32 v56, v247, v56
    v_mul_f32 v57, v247, v57
    v_mul_f32 v58, v247, v58
    v_mul_f32 v59, v247, v59
    v_mfma_f32_16x16x32_bf16 v[68:71], v[100:103], v[128:131], v[68:71]
    v_mul_f32 v72, v252, v72
    v_mul_f32 v73, v252, v73
    v_mul_f32 v74, v252, v74
    v_mul_f32 v75, v252, v75
    v_mfma_f32_16x16x32_bf16 v[84:87], v[100:103], v[132:135], v[84:87]
    v_mul_f32 v88, v255, v88
    v_mul_f32 v89, v255, v89
    v_mul_f32 v90, v255, v90
    v_mul_f32 v91, v255, v91
    v_add_u32 v241, 0x10000, v241
    ds_read_b64_tr_b16 v[100:101], v241 offset:0
    ds_read_b64_tr_b16 v[102:103], v241 offset:1024
    s_waitcnt lgkmcnt(6)
    v_mfma_f32_16x16x32_bf16 v[8:11], v[104:107], v[112:115], v[8:11]
    v_mul_f32 v12, v244, v12
    v_mul_f32 v13, v244, v13
    v_mul_f32 v14, v244, v14
    v_mul_f32 v15, v244, v15
    v_mfma_f32_16x16x32_bf16 v[24:27], v[104:107], v[116:119], v[24:27]
    v_mul_f32 v28, v245, v28
    v_mul_f32 v29, v245, v29
    v_mul_f32 v30, v245, v30
    v_mul_f32 v31, v245, v31
    v_mfma_f32_16x16x32_bf16 v[40:43], v[104:107], v[120:123], v[40:43]
    v_mul_f32 v44, v246, v44
    v_mul_f32 v45, v246, v45
    v_mul_f32 v46, v246, v46
    v_mul_f32 v47, v246, v47
    v_mfma_f32_16x16x32_bf16 v[56:59], v[104:107], v[124:127], v[56:59]
    v_mul_f32 v60, v247, v60
    v_mul_f32 v61, v247, v61
    v_mul_f32 v62, v247, v62
    v_mul_f32 v63, v247, v63
    v_mfma_f32_16x16x32_bf16 v[72:75], v[104:107], v[128:131], v[72:75]
    v_mul_f32 v76, v252, v76
    v_mul_f32 v77, v252, v77
    v_mul_f32 v78, v252, v78
    v_mul_f32 v79, v252, v79
    v_mfma_f32_16x16x32_bf16 v[88:91], v[104:107], v[132:135], v[88:91]
    v_mul_f32 v92, v255, v92
    v_mul_f32 v93, v255, v93
    v_mul_f32 v94, v255, v94
    v_mul_f32 v95, v255, v95
    v_add_u32 v242, 0x10000, v242
    ds_read_b64_tr_b16 v[104:105], v242 offset:0
    ds_read_b64_tr_b16 v[106:107], v242 offset:1024
    s_waitcnt lgkmcnt(6)
    v_mfma_f32_16x16x32_bf16 v[12:15], v[108:111], v[112:115], v[12:15]
    v_mfma_f32_16x16x32_bf16 v[28:31], v[108:111], v[116:119], v[28:31]
    v_mfma_f32_16x16x32_bf16 v[44:47], v[108:111], v[120:123], v[44:47]
    v_mfma_f32_16x16x32_bf16 v[60:63], v[108:111], v[124:127], v[60:63]
    v_mfma_f32_16x16x32_bf16 v[76:79], v[108:111], v[128:131], v[76:79]
    v_mfma_f32_16x16x32_bf16 v[92:95], v[108:111], v[132:135], v[92:95]
    v_add_u32 v243, 0x10000, v243
    ds_read_b64_tr_b16 v[108:109], v243 offset:0
    ds_read_b64_tr_b16 v[110:111], v243 offset:1024
    s_waitcnt vmcnt(32)
    s_waitcnt lgkmcnt(6)
    v_mfma_f32_16x16x32_bf16 v[0:3], v[96:99], v[208:211], v[0:3]
    v_mfma_f32_16x16x32_bf16 v[16:19], v[96:99], v[212:215], v[16:19]
    v_mfma_f32_16x16x32_bf16 v[32:35], v[96:99], v[216:219], v[32:35]
    v_mfma_f32_16x16x32_bf16 v[48:51], v[96:99], v[220:223], v[48:51]
    v_mfma_f32_16x16x32_bf16 v[64:67], v[96:99], v[224:227], v[64:67]
    v_mfma_f32_16x16x32_bf16 v[80:83], v[96:99], v[228:231], v[80:83]
    ds_read_b64_tr_b16 v[96:97], v240 offset:16384
    ds_read_b64_tr_b16 v[98:99], v240 offset:17408
    s_waitcnt lgkmcnt(6)
    v_mfma_f32_16x16x32_bf16 v[4:7], v[100:103], v[208:211], v[4:7]
    v_mfma_f32_16x16x32_bf16 v[20:23], v[100:103], v[212:215], v[20:23]
    v_mfma_f32_16x16x32_bf16 v[36:39], v[100:103], v[216:219], v[36:39]
    v_mfma_f32_16x16x32_bf16 v[52:55], v[100:103], v[220:223], v[52:55]
    v_mfma_f32_16x16x32_bf16 v[68:71], v[100:103], v[224:227], v[68:71]
    v_mfma_f32_16x16x32_bf16 v[84:87], v[100:103], v[228:231], v[84:87]
    ds_read_b64_tr_b16 v[100:101], v241 offset:16384
    ds_read_b64_tr_b16 v[102:103], v241 offset:17408
    s_waitcnt lgkmcnt(6)
    v_mfma_f32_16x16x32_bf16 v[8:11], v[104:107], v[208:211], v[8:11]
    v_mfma_f32_16x16x32_bf16 v[24:27], v[104:107], v[212:215], v[24:27]
    v_mfma_f32_16x16x32_bf16 v[40:43], v[104:107], v[216:219], v[40:43]
    v_mfma_f32_16x16x32_bf16 v[56:59], v[104:107], v[220:223], v[56:59]
    v_mfma_f32_16x16x32_bf16 v[72:75], v[104:107], v[224:227], v[72:75]
    v_mfma_f32_16x16x32_bf16 v[88:91], v[104:107], v[228:231], v[88:91]
    ds_read_b64_tr_b16 v[104:105], v242 offset:16384
    ds_read_b64_tr_b16 v[106:107], v242 offset:17408
    s_waitcnt lgkmcnt(6)
    v_mfma_f32_16x16x32_bf16 v[12:15], v[108:111], v[208:211], v[12:15]
    v_mfma_f32_16x16x32_bf16 v[28:31], v[108:111], v[212:215], v[28:31]
    v_mfma_f32_16x16x32_bf16 v[44:47], v[108:111], v[216:219], v[44:47]
    v_mfma_f32_16x16x32_bf16 v[60:63], v[108:111], v[220:223], v[60:63]
    v_mfma_f32_16x16x32_bf16 v[76:79], v[108:111], v[224:227], v[76:79]
    v_mfma_f32_16x16x32_bf16 v[92:95], v[108:111], v[228:231], v[92:95]
    ds_read_b64_tr_b16 v[108:109], v243 offset:16384
    ds_read_b64_tr_b16 v[110:111], v243 offset:17408
    s_waitcnt vmcnt(12)
    s_waitcnt lgkmcnt(6)
    v_mfma_f32_16x16x32_bf16 v[0:3], v[96:99], v[136:139], v[0:3]
    v_mfma_f32_16x16x32_bf16 v[16:19], v[96:99], v[140:143], v[16:19]
    v_mfma_f32_16x16x32_bf16 v[32:35], v[96:99], v[144:147], v[32:35]
    v_mfma_f32_16x16x32_bf16 v[48:51], v[96:99], v[148:151], v[48:51]
    v_mfma_f32_16x16x32_bf16 v[64:67], v[96:99], v[152:155], v[64:67]
    v_mfma_f32_16x16x32_bf16 v[80:83], v[96:99], v[156:159], v[80:83]
    ds_read_b64_tr_b16 v[96:97], v240 offset:32768
    ds_read_b64_tr_b16 v[98:99], v240 offset:33792
    ds_read_b64_tr_b16 v[208:209], v240 offset:49152
    ds_read_b64_tr_b16 v[210:211], v240 offset:50176
    s_waitcnt lgkmcnt(8)
    v_mfma_f32_16x16x32_bf16 v[4:7], v[100:103], v[136:139], v[4:7]
    v_mfma_f32_16x16x32_bf16 v[20:23], v[100:103], v[140:143], v[20:23]
    v_mfma_f32_16x16x32_bf16 v[36:39], v[100:103], v[144:147], v[36:39]
    v_mfma_f32_16x16x32_bf16 v[52:55], v[100:103], v[148:151], v[52:55]
    v_mfma_f32_16x16x32_bf16 v[68:71], v[100:103], v[152:155], v[68:71]
    v_mfma_f32_16x16x32_bf16 v[84:87], v[100:103], v[156:159], v[84:87]
    ds_read_b64_tr_b16 v[100:101], v241 offset:32768
    ds_read_b64_tr_b16 v[102:103], v241 offset:33792
    ds_read_b64_tr_b16 v[212:213], v241 offset:49152
    ds_read_b64_tr_b16 v[214:215], v241 offset:50176
    s_waitcnt lgkmcnt(10)
    v_mfma_f32_16x16x32_bf16 v[8:11], v[104:107], v[136:139], v[8:11]
    v_mfma_f32_16x16x32_bf16 v[24:27], v[104:107], v[140:143], v[24:27]
    v_mfma_f32_16x16x32_bf16 v[40:43], v[104:107], v[144:147], v[40:43]
    v_mfma_f32_16x16x32_bf16 v[56:59], v[104:107], v[148:151], v[56:59]
    v_mfma_f32_16x16x32_bf16 v[72:75], v[104:107], v[152:155], v[72:75]
    v_mfma_f32_16x16x32_bf16 v[88:91], v[104:107], v[156:159], v[88:91]
    ds_read_b64_tr_b16 v[104:105], v242 offset:32768
    ds_read_b64_tr_b16 v[106:107], v242 offset:33792
    ds_read_b64_tr_b16 v[216:217], v242 offset:49152
    ds_read_b64_tr_b16 v[218:219], v242 offset:50176
    s_waitcnt lgkmcnt(12)
    v_mfma_f32_16x16x32_bf16 v[12:15], v[108:111], v[136:139], v[12:15]
    v_mfma_f32_16x16x32_bf16 v[28:31], v[108:111], v[140:143], v[28:31]
    v_mfma_f32_16x16x32_bf16 v[44:47], v[108:111], v[144:147], v[44:47]
    v_mfma_f32_16x16x32_bf16 v[60:63], v[108:111], v[148:151], v[60:63]
    v_mfma_f32_16x16x32_bf16 v[76:79], v[108:111], v[152:155], v[76:79]
    v_mfma_f32_16x16x32_bf16 v[92:95], v[108:111], v[156:159], v[92:95]
    ds_read_b64_tr_b16 v[108:109], v243 offset:32768
    ds_read_b64_tr_b16 v[110:111], v243 offset:33792
    ds_read_b64_tr_b16 v[220:221], v243 offset:49152
    ds_read_b64_tr_b16 v[222:223], v243 offset:50176
    s_waitcnt vmcnt(0)
    s_waitcnt lgkmcnt(14)
    v_mfma_f32_16x16x32_bf16 v[0:3], v[96:99], v[160:163], v[0:3]
    v_mfma_f32_16x16x32_bf16 v[16:19], v[96:99], v[164:167], v[16:19]
    v_mfma_f32_16x16x32_bf16 v[32:35], v[96:99], v[168:171], v[32:35]
    v_mfma_f32_16x16x32_bf16 v[48:51], v[96:99], v[172:175], v[48:51]
    v_mfma_f32_16x16x32_bf16 v[64:67], v[96:99], v[176:179], v[64:67]
    v_mfma_f32_16x16x32_bf16 v[80:83], v[96:99], v[180:183], v[80:83]
    s_waitcnt lgkmcnt(12)
    v_mfma_f32_16x16x32_bf16 v[32:35], v[208:211], v[192:195], v[32:35]
    v_mfma_f32_16x16x32_bf16 v[48:51], v[208:211], v[196:199], v[48:51]
    v_mfma_f32_16x16x32_bf16 v[64:67], v[208:211], v[200:203], v[64:67]
    v_mfma_f32_16x16x32_bf16 v[80:83], v[208:211], v[204:207], v[80:83]
    v_mfma_f32_16x16x32_bf16 v[0:3], v[208:211], v[184:187], v[0:3]
    v_mfma_f32_16x16x32_bf16 v[16:19], v[208:211], v[188:191], v[16:19]
    s_waitcnt lgkmcnt(10)
    v_mfma_f32_16x16x32_bf16 v[4:7], v[100:103], v[160:163], v[4:7]
    v_mfma_f32_16x16x32_bf16 v[20:23], v[100:103], v[164:167], v[20:23]
    v_mfma_f32_16x16x32_bf16 v[36:39], v[100:103], v[168:171], v[36:39]
    s_waitcnt lgkmcnt(0)
    ds_write_b128 v248, v[32:35] offset:0
    v_mfma_f32_16x16x32_bf16 v[52:55], v[100:103], v[172:175], v[52:55]
    v_mfma_f32_16x16x32_bf16 v[68:71], v[100:103], v[176:179], v[68:71]
    ds_write_b128 v248, v[48:51] offset:16384
    v_mfma_f32_16x16x32_bf16 v[84:87], v[100:103], v[180:183], v[84:87]
    v_mfma_f32_16x16x32_bf16 v[36:39], v[212:215], v[192:195], v[36:39]
    ds_write_b128 v248, v[64:67] offset:32768
    v_mfma_f32_16x16x32_bf16 v[52:55], v[212:215], v[196:199], v[52:55]
    v_mfma_f32_16x16x32_bf16 v[68:71], v[212:215], v[200:203], v[68:71]
    ds_write_b128 v248, v[80:83] offset:49152
    v_mfma_f32_16x16x32_bf16 v[84:87], v[212:215], v[204:207], v[84:87]
    v_mfma_f32_16x16x32_bf16 v[4:7], v[212:215], v[184:187], v[4:7]
    v_add_u32 v248, 0x1c000, v248
    ds_write_b128 v248, v[0:3] offset:0
    v_mfma_f32_16x16x32_bf16 v[20:23], v[212:215], v[188:191], v[20:23]
    ds_write_b128 v248, v[16:19] offset:16384
    v_mfma_f32_16x16x32_bf16 v[8:11], v[104:107], v[160:163], v[8:11]
    v_mfma_f32_16x16x32_bf16 v[24:27], v[104:107], v[164:167], v[24:27]
    v_mfma_f32_16x16x32_bf16 v[40:43], v[104:107], v[168:171], v[40:43]
    ds_write_b128 v249, v[36:39] offset:1024
    v_mfma_f32_16x16x32_bf16 v[56:59], v[104:107], v[172:175], v[56:59]
    v_mfma_f32_16x16x32_bf16 v[72:75], v[104:107], v[176:179], v[72:75]
    ds_write_b128 v249, v[52:55] offset:17408
    v_mfma_f32_16x16x32_bf16 v[88:91], v[104:107], v[180:183], v[88:91]
    v_mfma_f32_16x16x32_bf16 v[40:43], v[216:219], v[192:195], v[40:43]
    ds_write_b128 v249, v[68:71] offset:33792
    v_mfma_f32_16x16x32_bf16 v[56:59], v[216:219], v[196:199], v[56:59]
    v_mfma_f32_16x16x32_bf16 v[72:75], v[216:219], v[200:203], v[72:75]
    ds_write_b128 v249, v[84:87] offset:50176
    v_mfma_f32_16x16x32_bf16 v[88:91], v[216:219], v[204:207], v[88:91]
    v_mfma_f32_16x16x32_bf16 v[8:11], v[216:219], v[184:187], v[8:11]
    v_add_u32 v249, 0x1c000, v249
    ds_write_b128 v249, v[4:7] offset:1024
    v_mfma_f32_16x16x32_bf16 v[24:27], v[216:219], v[188:191], v[24:27]
    ds_write_b128 v249, v[20:23] offset:17408
    v_mfma_f32_16x16x32_bf16 v[12:15], v[108:111], v[160:163], v[12:15]
    v_mfma_f32_16x16x32_bf16 v[28:31], v[108:111], v[164:167], v[28:31]
    v_mfma_f32_16x16x32_bf16 v[44:47], v[108:111], v[168:171], v[44:47]
    ds_write_b128 v250, v[40:43] offset:2048
    v_mfma_f32_16x16x32_bf16 v[60:63], v[108:111], v[172:175], v[60:63]
    v_mfma_f32_16x16x32_bf16 v[76:79], v[108:111], v[176:179], v[76:79]
    ds_write_b128 v250, v[56:59] offset:18432
    v_mfma_f32_16x16x32_bf16 v[92:95], v[108:111], v[180:183], v[92:95]
    v_mfma_f32_16x16x32_bf16 v[44:47], v[220:223], v[192:195], v[44:47]
    ds_write_b128 v250, v[72:75] offset:34816
    v_mfma_f32_16x16x32_bf16 v[60:63], v[220:223], v[196:199], v[60:63]
    v_mfma_f32_16x16x32_bf16 v[76:79], v[220:223], v[200:203], v[76:79]
    ds_write_b128 v250, v[88:91] offset:51200
    v_mfma_f32_16x16x32_bf16 v[92:95], v[220:223], v[204:207], v[92:95]
    v_mfma_f32_16x16x32_bf16 v[12:15], v[220:223], v[184:187], v[12:15]
    v_add_u32 v250, 0x1c000, v250
    ds_write_b128 v250, v[8:11] offset:2048
    v_mfma_f32_16x16x32_bf16 v[28:31], v[220:223], v[188:191], v[28:31]
    ds_write_b128 v250, v[24:27] offset:18432
    s_nop 7
    ds_write_b128 v251, v[44:47] offset:3072
    ds_write_b128 v251, v[60:63] offset:19456
    ds_write_b128 v251, v[76:79] offset:35840
    ds_write_b128 v251, v[92:95] offset:52224
    v_add_u32 v251, 0x1c000, v251
    ds_write_b128 v251, v[12:15] offset:3072
    ds_write_b128 v251, v[28:31] offset:19456
    s_waitcnt lgkmcnt(0)
    s_barrier
    s_endpgm
K_SPARE:
    s_sub_u32 s46, s22, 30
    s_lshl_b32 s46, s46, 9
    v_add_u32 v1, s46, v0
    v_lshlrev_b32 v1, 7, v1
    s_waitcnt lgkmcnt(0)
    s_mov_b32 s24, s14
    s_mov_b32 s25, s15
    s_mov_b32 s26, 0x1e0000
    s_mov_b32 s27, 0x20000
    s_mov_b32 s28, s8
    s_mov_b32 s29, s9
    s_mov_b32 s30, 0xc8000
    s_mov_b32 s31, 0x20000
    s_mov_b32 s32, s4
    s_mov_b32 s33, s5
    s_mov_b32 s34, 0x280000
    s_mov_b32 s35, 0x20000
    s_mov_b32 s36, s6
    s_mov_b32 s37, s7
    s_mov_b32 s38, 0x258000
    s_mov_b32 s39, 0x20000
    s_mov_b32 s40, s12
    s_mov_b32 s41, s13
    s_mov_b32 s42, 0x1e0000
    s_mov_b32 s43, 0x20000
    s_sub_u32 s46, s2, 240
    s_lshl_b32 s46, s46, 1
    s_and_b32 s47, s20, 1
    s_add_u32 s46, s46, s47
    s_lshl_b32 s46, s46, 6
    v_add_u32 v4, s46, v254
    s_lshr_b32 s47, s20, 1
    s_cmp_eq_u32 s47, 0
    s_cbranch_scc0 KP0
    s_cmp_ge_u32 s46, 2048
    s_cbranch_scc1 KP_END
    v_mul_u32_u24 v4, 1280, v4
    s_mov_b32 s48, 640
    buffer_load_dword v3, v4, s[32:35], s48 offen
    s_mov_b32 s48, 768
    buffer_load_dword v3, v4, s[32:35], s48 offen
    s_mov_b32 s48, 896
    buffer_load_dword v3, v4, s[32:35], s48 offen
    s_mov_b32 s48, 1024
    buffer_load_dword v3, v4, s[32:35], s48 offen
    s_mov_b32 s48, 1152
    buffer_load_dword v3, v4, s[32:35], s48 offen
    s_branch KP_END
KP0:
    s_cmp_eq_u32 s47, 1
    s_cbranch_scc0 KP1
    s_cmp_ge_u32 s46, 1920
    s_cbranch_scc1 KP_END
    v_mul_u32_u24 v4, 128, v4
    s_mov_b32 s48, 1228800
    buffer_load_dword v3, v4, s[36:39], s48 offen
    s_mov_b32 s48, 1474560
    buffer_load_dword v3, v4, s[36:39], s48 offen
    s_mov_b32 s48, 1720320
    buffer_load_dword v3, v4, s[36:39], s48 offen
    s_mov_b32 s48, 1966080
    buffer_load_dword v3, v4, s[36:39], s48 offen
    s_mov_b32 s48, 2211840
    buffer_load_dword v3, v4, s[36:39], s48 offen
    s_branch KP_END
KP1:
    s_cmp_eq_u32 s47, 2
    s_cbranch_scc0 KP2
    s_cmp_ge_u32 s46, 1536
    s_cbranch_scc1 KP_END
    v_mul_u32_u24 v4, 128, v4
    s_mov_b32 s48, 983040
    buffer_load_dword v3, v4, s[40:43], s48 offen
    s_mov_b32 s48, 1179648
    buffer_load_dword v3, v4, s[40:43], s48 offen
    s_mov_b32 s48, 1376256
    buffer_load_dword v3, v4, s[40:43], s48 offen
    s_mov_b32 s48, 1572864
    buffer_load_dword v3, v4, s[40:43], s48 offen
    s_mov_b32 s48, 1769472
    buffer_load_dword v3, v4, s[40:43], s48 offen
    s_branch KP_END
KP2:
KP_END:
    s_barrier
    s_lshl_b32 s46, s21, 1
    s_mov_b32 s49, s21
    s_cmp_ge_u32 s46, 15
    s_cselect_b32 s46, 0, s46
    s_lshl_b32 s47, s46, 17
    v_add_u32 v2, s47, v1
    buffer_load_dword v3, v2, s[24:27], 0 offen
    s_add_u32 s46, s46, 1
    s_waitcnt vmcnt(1)
    s_cmp_ge_u32 s46, 15
    s_cselect_b32 s46, 0, s46
    s_lshl_b32 s47, s46, 17
    v_add_u32 v2, s47, v1
    buffer_load_dword v3, v2, s[24:27], 0 offen
    s_add_u32 s46, s46, 1
    s_waitcnt vmcnt(1)
    s_cmp_ge_u32 s49, 7
    s_cselect_b32 s49, 0, s49
    s_lshl_b32 s47, s49, 17
    v_add_u32 v2, s47, v1
    buffer_load_dword v3, v2, s[28:31], 0 offen
    s_add_u32 s49, s49, 1
    s_waitcnt vmcnt(1)
K_END:
    s_endpgm
.section .rodata,"a"
.p2align 6
.amdhsa_kernel gated_mix__sliding_local_dilated__dense_activation_relu__prompt_kernel
  .amdhsa_next_free_vgpr 256
  .amdhsa_next_free_sgpr 102
  .amdhsa_accum_offset 256
  .amdhsa_group_segment_fixed_size 0
  .amdhsa_kernarg_size 80
  .amdhsa_user_sgpr_count 2
  .amdhsa_user_sgpr_kernarg_segment_ptr 1
  .amdhsa_system_sgpr_workgroup_id_x 1
.end_amdhsa_kernel
```
